```python
import torch

def _softmax(x, axis=-1):
    return torch.softmax(x, dim=axis)
def _gelu(x):
    return torch.nn.functional.gelu(x, approximate="tanh")
def _silu(x):
    return torch.nn.functional.silu(x)
def _sigmoid(x):
    return torch.sigmoid(x)
def _layernorm(x, axis=-1, eps=1e-5):
    m = x.mean(dim=axis, keepdim=True)
    v = x.var(dim=axis, keepdim=True, unbiased=False)
    return (x - m) / torch.sqrt(v + eps)
def _scatter_add(tgt, idx, src, axis=0):
    return tgt.clone().index_add_(axis, idx, src)
def _segment_sum(src, seg, n):
    out = torch.zeros((n,) + src.shape[1:], dtype=src.dtype)
    return out.index_add_(0, seg, src)
def _pad(x, pw):
    flat = tuple(v for pair in reversed(pw) for v in pair)
    return torch.nn.functional.pad(x, flat)

kernel_name = 'interleave_layers__spectral_fnet__spectral_fnet__prompt'

def setup_inputs():

    _w = (lambda a: (lambda t: t.to(torch.bfloat16) if t.is_floating_point() else t)(torch.as_tensor(a)))
    def _A_setup():
        B, S, D = 1, 2048, 1024
        ns = torch.arange(S)[:, None] * torch.arange(S)[None, :]
        nd = torch.arange(D)[:, None] * torch.arange(D)[None, :]
        Ws_re = torch.cos(-2.0 * torch.pi * ns / S).to(float)
        Ws_im = torch.sin(-2.0 * torch.pi * ns / S).to(float)
        Wd_re = torch.cos(-2.0 * torch.pi * nd / D).to(float)
        Wd_im = torch.sin(-2.0 * torch.pi * nd / D).to(float)
        return {
            "x": _w((lambda *s: torch.randn(*s, dtype=torch.bfloat16) * 0.05)(B, S, D)),
            "dft_seq_re": _w(Ws_re),
            "dft_seq_im": _w(Ws_im),
            "dft_hid_re": _w(Wd_re),
            "dft_hid_im": _w(Wd_im),
        }
    _A_in = _A_setup()

    def _B_setup():
        B, S, D = 1, 2048, 1024
        ns = torch.arange(S)[:, None] * torch.arange(S)[None, :]
        nd = torch.arange(D)[:, None] * torch.arange(D)[None, :]
        Ws_re = torch.cos(-2.0 * torch.pi * ns / S).to(float)
        Ws_im = torch.sin(-2.0 * torch.pi * ns / S).to(float)
        Wd_re = torch.cos(-2.0 * torch.pi * nd / D).to(float)
        Wd_im = torch.sin(-2.0 * torch.pi * nd / D).to(float)
        return {
            "x": _w((lambda *s: torch.randn(*s, dtype=torch.bfloat16) * 0.05)(B, S, D)),
            "dft_seq_re": _w(Ws_re),
            "dft_seq_im": _w(Ws_im),
            "dft_hid_re": _w(Wd_re),
            "dft_hid_im": _w(Wd_im),
        }
    _B_in = _B_setup()

    return {
        "A_x": _A_in["x"],
        "A_dft_seq_re": _A_in["dft_seq_re"],
        "A_dft_seq_im": _A_in["dft_seq_im"],
        "A_dft_hid_re": _A_in["dft_hid_re"],
        "A_dft_hid_im": _A_in["dft_hid_im"],
        "B_x": _B_in["x"],
        "B_dft_seq_re": _B_in["dft_seq_re"],
        "B_dft_seq_im": _B_in["dft_seq_im"],
        "B_dft_hid_re": _B_in["dft_hid_re"],
        "B_dft_hid_im": _B_in["dft_hid_im"],
    }

def reference(A_x, A_dft_seq_re, A_dft_seq_im, A_dft_hid_re, A_dft_hid_im, B_x, B_dft_seq_re, B_dft_seq_im, B_dft_hid_re, B_dft_hid_im):
    def _A_ref(x, dft_seq_re, dft_seq_im, dft_hid_re, dft_hid_im):
        a = torch.einsum("bsd,ed->bse", x, dft_hid_re)
        b = torch.einsum("bsd,ed->bse", x, dft_hid_im)
        y = torch.einsum("ts,bse->bte", dft_seq_re, a) - torch.einsum("ts,bse->bte", dft_seq_im, b)
        return y

    def _B_ref(x, dft_seq_re, dft_seq_im, dft_hid_re, dft_hid_im):
        a = torch.einsum("bsd,ed->bse", x, dft_hid_re)
        b = torch.einsum("bsd,ed->bse", x, dft_hid_im)
        y = torch.einsum("ts,bse->bte", dft_seq_re, a) - torch.einsum("ts,bse->bte", dft_seq_im, b)
        return y

    x = A_x
    x = x + _A_ref(_layernorm(x, axis=-1), A_dft_seq_re, A_dft_seq_im, A_dft_hid_re, A_dft_hid_im)
    x = x + _B_ref(_layernorm(x, axis=-1), B_dft_seq_re, B_dft_seq_im, B_dft_hid_re, B_dft_hid_im)
    x = x + _A_ref(_layernorm(x, axis=-1), A_dft_seq_re, A_dft_seq_im, A_dft_hid_re, A_dft_hid_im)
    x = x + _B_ref(_layernorm(x, axis=-1), B_dft_seq_re, B_dft_seq_im, B_dft_hid_re, B_dft_hid_im)
    return x
```

```asm
; @launch grid=(256,1,1) block=(256,1,1) lds=33792
.amdgcn_target "amdgcn-amd-amdhsa--gfx950"
.text
.globl interleave_layers__spectral_fnet__spectral_fnet__prompt_kernel
.p2align 8
.type interleave_layers__spectral_fnet__spectral_fnet__prompt_kernel,@function
interleave_layers__spectral_fnet__spectral_fnet__prompt_kernel:
    s_cmp_ge_u32 s2, 256
    s_cbranch_scc1 MAIN_END
    s_load_dwordx2 s[84:85], s[0:1], 0
    s_load_dwordx2 s[4:5], s[0:1], 96
    s_load_dwordx4 s[8:11], s[0:1], 80
    v_lshrrev_b32 v164, 6, v0
    v_and_b32 v1, 63, v0
    v_readfirstlane_b32 s19, v164
    s_mov_b32 s86, 0x400000
    s_mov_b32 s87, 0x00020000
    s_mov_b32 s6, 33554432
    s_mov_b32 s7, 0x00020000
    v_lshlrev_b32 v180, 4, v1
    s_and_b32 s16, s2, 7
    s_lshl_b32 s16, s16, 1
    s_bfe_u32 s26, s2, 0x10003
    s_or_b32 s16, s16, s26
    s_lshr_b32 s17, s2, 4
    s_lshl_b32 s18, s16, 4
    s_or_b32 s18, s18, s17
    s_lshl_b32 s35, s17, 2
    s_add_u32 s35, s35, s19
    s_lshr_b32 s26, s35, 5
    s_and_b32 s27, s35, 31
    s_lshl_b32 s36, s27, 6
    s_lshl_b32 s37, s26, 5
    s_add_u32 s37, s37, s16
    s_cmp_ge_u32 s27, 16
    s_cselect_b32 s27, -992, 0
    s_cmp_eq_u32 s26, 1
    s_cselect_b32 s27, 16, s27
    s_cmp_eq_u32 s16, 0
    s_cselect_b32 s37, s27, s37
    s_add_u32 s36, s36, s37
    s_sub_u32 s37, 2048, s36
    s_cmp_eq_u32 s36, 0
    s_cselect_b32 s37, 1024, s37
    s_lshl_b32 s36, s36, 11
    s_lshl_b32 s37, s37, 11
    v_and_b32 v2, 15, v0
    v_lshrrev_b32 v3, 4, v1
    s_lshl_b32 s50, s16, 21
    s_waitcnt lgkmcnt(0)
    buffer_load_dwordx4 v[24:27], v180, s[84:87], s36 offen
    buffer_load_dwordx4 v[28:31], v180, s[84:87], s36 offen offset:1024
    buffer_load_dwordx4 v[32:35], v180, s[84:87], s37 offen
    buffer_load_dwordx4 v[36:39], v180, s[84:87], s37 offen offset:1024
    s_load_dword s41, s[4:5], 425984
    s_mul_i32 s55, s17, 16384
    s_add_u32 s55, s55, s50
    s_add_u32 s55, s55, 0
    v_lshlrev_b32 v250, 6, v1
    s_getreg_b32 s94, hwreg(HW_REG_XCC_ID, 0, 4)
    s_mov_b32 s12, s10
    s_mov_b32 s13, s11
    s_mov_b32 s10, 0x400000
    s_mov_b32 s11, 0x00020000
    s_mov_b32 s14, 256
    s_mov_b32 s15, 0x00020000
    v_mov_b32 v20, -1
    v_mov_b32 v21, -1
    v_mov_b32 v22, -1
    v_mov_b32 v23, -1
    s_lshl_b32 s26, s17, 13
    s_add_u32 s26, s26, s50
    s_lshr_b32 s27, s19, 1
    s_lshl_b32 s27, s27, 12
    s_add_u32 s26, s26, s27
    s_and_b32 s27, s19, 1
    s_lshl_b32 s28, s27, 8
    s_add_u32 s26, s26, s28
    v_lshlrev_b32 v166, 4, v2
    v_lshl_add_u32 v5, v3, 10, v166
    v_add_u32 v5, s26, v5
    s_mov_b32 s21, 524288
    s_mov_b32 s22, 4718592
    buffer_store_dwordx4 v[20:23], v5, s[4:7], s21 offen sc1
    buffer_store_dwordx4 v[20:23], v5, s[4:7], s21 offen offset:512 sc1
    s_lshl_b32 s26, s17, 10
    s_min_u32 s28, s19, 2
    s_mul_i32 s28, s28, 16384
    s_add_u32 s26, s26, s50
    s_add_u32 s28, s28, s26
    s_add_u32 s28, s28, 458752
    buffer_store_dwordx4 v[20:23], v180, s[4:7], s28 offen sc1
    s_mov_b32 s25, 0
    s_mov_b32 s20, 0
    s_mov_b32 s23, 458752
    s_lshl_b32 s28, s19, 4
    v_add_u32 v165, s28, v2
    v_lshlrev_b32 v167, 4, v165
    v_lshl_add_u32 v6, v3, 2, v167
    v_add_u32 v6, s26, v6
    v_lshl_add_u32 v7, v3, 12, v167
    v_add_u32 v7, s50, v7
    v_lshrrev_b32 v166, 5, v1
    v_lshlrev_b32 v4, 21, v166
    v_bfe_u32 v166, v1, 1, 4
    v_lshl_add_u32 v4, v166, 13, v4
    v_and_b32 v166, 1, v1
    v_lshl_add_u32 v4, v166, 4, v4
    s_lshl_b32 s28, s19, 23
    s_lshl_b32 s29, s18, 5
    s_add_u32 s28, s28, s29
    v_add_u32 v4, s28, v4
    s_lshl_b32 s28, s19, 11
    s_add_u32 s28, s28, 8192
    v_add_u32 v13, s28, v180
    v_lshrrev_b32 v166, 2, v165
    v_lshlrev_b32 v8, 14, v166
    v_and_b32 v166, 3, v2
    v_lshl_add_u32 v8, v166, 6, v8
    v_lshl_add_u32 v8, v3, 4, v8
    v_add_u32 v8, s26, v8
    v_lshrrev_b32 v166, 2, v1
    v_lshlrev_b32 v9, 10, v166
    v_and_b32 v166, 3, v1
    v_lshl_add_u32 v9, v166, 4, v9
    s_lshl_b32 s28, s17, 14
    s_add_u32 s28, s28, s50
    s_lshl_b32 s29, s19, 6
    s_add_u32 s28, s28, s29
    v_add_u32 v9, s28, v9
    v_lshlrev_b32 v166, 4, v2
    v_lshl_add_u32 v12, v3, 8, v166
    v_lshl_add_u32 v14, v3, 9, v166
    s_lshl_b32 s28, s27, 10
    v_add_u32 v12, s28, v12
    v_add_u32 v14, 8192, v14
    v_lshrrev_b32 v167, 1, v3
    v_lshl_add_u32 v166, v167, 8, v166
    v_and_b32 v167, 1, v3
    v_lshl_add_u32 v166, v167, 3, v166
    s_lshr_b32 s26, s19, 1
    s_lshl_b32 s26, s26, 11
    s_lshl_b32 s28, s27, 9
    s_add_u32 s26, s26, s28
    s_lshl_b32 s28, s19, 12
    s_lshl_b32 s29, s16, 2
    s_or_b32 s30, s29, s19
    s_cmp_lt_u32 s30, 2
    s_cselect_b32 s26, s28, s26
    s_cselect_b32 s28, 1, 8
    s_lshl_b32 s28, s28, 9
    s_add_u32 s28, s28, s26
    v_add_u32 v10, s26, v166
    v_add_u32 v11, s28, v166
    s_cmp_eq_u32 s30, 0
    s_cselect_b32 s42, 0x00010001, 0
    s_mov_b32 s43, s42
    v_mov_b32 v148, 1.0
    v_mov_b32 v149, 1.0
    v_mov_b32 v150, 1.0
    v_mov_b32 v151, 1.0
    v_mov_b32 v152, 1.0
    v_mov_b32 v153, 1.0
    s_cmp_eq_u32 s17, 0
    s_cselect_b32 exec_lo, 0xffff, 0
    s_mov_b32 exec_hi, 0
    v_mov_b32 v148, 0
    v_mov_b32 v150, 0
    s_and_b32 exec_lo, exec_lo, s42
    v_mov_b32 v150, 1.0
    v_mov_b32 v152, 0
    s_mov_b64 exec, -1
    v_mov_b32 v244, 0
    v_cvt_f32_u32 v174, v3
    v_mul_f32 v174, 0x41000000, v174
    s_cmp_eq_u32 s17, 0
    s_cbranch_scc1 GCOL0
    v_lshrrev_b32 v166, 1, v2
    v_cvt_f32_u32 v168, v166
    v_and_b32 v167, 1, v2
    v_cvt_f32_u32 v169, v167
    v_mul_f32 v168, 0x3d000000, v168
    v_mul_f32 v169, 0x3e800000, v169
    v_add_f32 v168, 0, v168
    v_cmp_eq_f32 vcc, 0, v168
    s_nop 1
    v_cndmask_b32 v166, 0, v169, vcc
    v_fmac_f32 v168, 2.0, v166
    v_sub_f32 v169, v169, v166
    v_fma_f32 v170, v168, v174, -v169
    v_cos_f32 v172, v170
    v_add_f32 v170, v170, v168
    v_cos_f32 v173, v170
    v_add_f32 v170, v170, v168
    v_cvt_pk_f16_f32 v56, v172, v173
    v_cos_f32 v172, v170
    v_add_f32 v170, v170, v168
    v_cos_f32 v173, v170
    v_add_f32 v170, v170, v168
    v_cvt_pk_f16_f32 v57, v172, v173
    v_cos_f32 v172, v170
    v_add_f32 v170, v170, v168
    v_cos_f32 v173, v170
    v_add_f32 v170, v170, v168
    v_cvt_pk_f16_f32 v58, v172, v173
    v_cos_f32 v172, v170
    v_add_f32 v170, v170, v168
    v_cos_f32 v173, v170
    s_nop 0
    v_cvt_pk_f16_f32 v59, v172, v173
    v_lshrrev_b32 v166, 1, v2
    v_cvt_f32_u32 v168, v166
    v_and_b32 v167, 1, v2
    v_cvt_f32_u32 v169, v167
    v_mul_f32 v168, 0x3d000000, v168
    v_mul_f32 v169, 0x3e800000, v169
    v_add_f32 v168, 0x3e800000, v168
    v_cmp_eq_f32 vcc, 0, v168
    s_nop 1
    v_cndmask_b32 v166, 0, v169, vcc
    v_fmac_f32 v168, 2.0, v166
    v_sub_f32 v169, v169, v166
    v_fma_f32 v170, v168, v174, -v169
    v_cos_f32 v172, v170
    v_add_f32 v170, v170, v168
    v_cos_f32 v173, v170
    v_add_f32 v170, v170, v168
    v_cvt_pk_f16_f32 v60, v172, v173
    v_cos_f32 v172, v170
    v_add_f32 v170, v170, v168
    v_cos_f32 v173, v170
    v_add_f32 v170, v170, v168
    v_cvt_pk_f16_f32 v61, v172, v173
    v_cos_f32 v172, v170
    v_add_f32 v170, v170, v168
    v_cos_f32 v173, v170
    v_add_f32 v170, v170, v168
    v_cvt_pk_f16_f32 v62, v172, v173
    v_cos_f32 v172, v170
    v_add_f32 v170, v170, v168
    v_cos_f32 v173, v170
    s_nop 0
    v_cvt_pk_f16_f32 v63, v172, v173
    v_mov_b64 v[64:65], v[56:57]
    v_mov_b64 v[66:67], v[58:59]
    v_mov_b64 v[68:69], v[60:61]
    v_mov_b64 v[70:71], v[62:63]
GCOL_DONE:
    s_lshr_b32 s26, s19, 1
    s_mul_i32 s26, s26, 0x3e800000
    v_lshrrev_b32 v166, 1, v2
    v_cvt_f32_u32 v168, v166
    v_and_b32 v167, 1, v2
    v_cvt_f32_u32 v169, v167
    v_mul_f32 v168, 0x3d000000, v168
    v_mul_f32 v169, 0x3e800000, v169
    v_add_f32 v168, s26, v168
    v_cmp_eq_f32 vcc, 0, v168
    s_nop 1
    v_cndmask_b32 v166, 0, v169, vcc
    v_fmac_f32 v168, 2.0, v166
    v_sub_f32 v169, v169, v166
    v_fma_f32 v170, v168, v174, -v169
    v_cos_f32 v172, v170
    v_add_f32 v170, v170, v168
    v_cos_f32 v173, v170
    v_add_f32 v170, v170, v168
    v_cvt_pk_f16_f32 v92, v172, v173
    v_cos_f32 v172, v170
    v_add_f32 v170, v170, v168
    v_cos_f32 v173, v170
    v_add_f32 v170, v170, v168
    v_cvt_pk_f16_f32 v93, v172, v173
    v_cos_f32 v172, v170
    v_add_f32 v170, v170, v168
    v_cos_f32 v173, v170
    v_add_f32 v170, v170, v168
    v_cvt_pk_f16_f32 v94, v172, v173
    v_cos_f32 v172, v170
    v_add_f32 v170, v170, v168
    v_cos_f32 v173, v170
    s_nop 0
    v_cvt_pk_f16_f32 v95, v172, v173
    s_cmp_eq_u32 s16, 0
    s_cbranch_scc1 GROW0
    v_mov_b64 v[88:89], v[92:93]
    v_mov_b64 v[96:97], v[92:93]
    v_mov_b64 v[90:91], v[94:95]
    v_mov_b64 v[98:99], v[94:95]
GROW_DONE:
    s_mul_i32 s38, s19, 4352
    s_add_u32 s38, s38, 16384
    v_lshrrev_b32 v142, 5, v1
    v_lshlrev_b32 v142, 5, v142
    v_lshl_add_u32 v132, v1, 4, v142
    v_add_u32 v132, s38, v132
    s_mov_b32 s44, 0xf0f0f0f0
    s_mov_b32 s45, 0xf0f0f0f0
    s_add_u32 s26, s38, 2176
    v_mov_b32 v142, s38
    v_mov_b32 v143, s26
    v_cndmask_b32 v140, v142, v143, s[44:45]
    s_cmp_eq_u32 s36, 0
    s_cselect_b32 s27, -1, 0
    s_xor_b32 s46, s44, s27
    s_mov_b32 s47, s46
    v_cndmask_b32 v141, v142, v143, s[46:47]
    v_and_b32 v142, 3, v1
    v_lshrrev_b32 v246, 3, v1
    v_lshl_add_u32 v134, v142, 8, v246
    v_add_u32 v142, 8, v134
    v_lshrrev_b32 v143, 8, v142
    v_lshl_add_u32 v143, v143, 5, v140
    v_lshl_add_u32 v137, v142, 1, v143
    v_sub_u32 v142, 792, v134
    v_lshrrev_b32 v143, 8, v142
    v_lshl_add_u32 v143, v143, 5, v141
    v_lshl_add_u32 v138, v142, 1, v143
    v_and_b32 v142, 1, v1
    v_lshlrev_b32 v142, 8, v142
    v_and_b32 v143, 2, v1
    s_mov_b64 exec, 0xff
    v_lshl_add_u32 v134, v143, 3, v142
    s_mov_b64 exec, -1
    v_lshrrev_b32 v143, 8, v134
    v_lshl_add_u32 v143, v143, 5, v140
    v_lshl_add_u32 v133, v134, 1, v143
    v_sub_u32 v142, 800, v134
    v_lshrrev_b32 v143, 8, v142
    v_lshl_add_u32 v143, v143, 5, v141
    v_lshl_add_u32 v135, v142, 1, v143
    v_sub_u32 v142, 1024, v134
    v_and_b32 v142, 1023, v142
    v_lshrrev_b32 v143, 8, v142
    v_lshl_add_u32 v143, v143, 5, v141
    v_lshl_add_u32 v136, v142, 1, v143
    v_mov_b32 v134, v133
    s_mov_b64 exec, 1
    v_add_u32 v134, 1088, v134
    s_and_b32 exec_lo, s46, 0x11
    v_add_u32 v136, 1088, v136
    s_mov_b64 exec, -1
    s_mov_b32 s26, 16384
    v_mul_lo_u32 v246, v246, s26
    v_and_b32 v142, 7, v1
    s_mul_i32 s26, s35, 252
    s_sub_u32 s26, 0x40000, s26
    v_lshrrev_b32 v46, 6, v246
    v_add_u32 v46, s26, v46
    s_mul_i32 s26, s35, 224
    s_sub_u32 s26, 0x41000, s26
    v_lshl_add_u32 v47, v142, 2, s26
    s_lshl_b32 s26, s17, 8
    s_add_u32 s26, s26, 0x40000
    v_lshl_add_u32 v214, v165, 2, s26
    v_lshlrev_b32 v215, 5, v165
    v_lshl_add_u32 v215, v3, 2, v215
    v_add_u32 v215, 0x41000, v215
    v_lshl_add_u32 v246, v142, 4, v246
    s_mul_i32 s51, s35, 256
    s_add_u32 s51, s51, s50
    s_add_u32 s53, s51, 131072
    s_add_u32 s51, s51, 0
    v_mul_u32_u24 v202, 256, v165
    v_lshl_add_u32 v202, v3, 4, v202
    s_waitcnt lgkmcnt(0)
    s_mul_i32 s41, s41, 0x19660d
    s_add_u32 s41, s41, 0x3c6ef35f
    s_add_u32 s95, s50, 395264
    v_lshlrev_b32 v245, 4, v2
    v_mov_b32 v248, s41
    v_mov_b32 v249, s94
    s_lshl_b32 exec_lo, 1, s17
    s_mov_b32 exec_hi, 0
    buffer_store_dwordx2 v[248:249], v245, s[4:7], s95 offen sc1
    s_mov_b64 exec, -1
    s_waitcnt vmcnt(4)
    ds_write_b128 v132, v[24:27]
    ds_write_b128 v132, v[28:31] offset:1088
    ds_write_b128 v132, v[32:35] offset:2176
    ds_write_b128 v132, v[36:39] offset:3264
    v_lshlrev_b32 v100, 16, v24
    v_and_b32 v101, 0xffff0000, v24
    v_lshlrev_b32 v102, 16, v25
    v_and_b32 v103, 0xffff0000, v25
    v_lshlrev_b32 v104, 16, v26
    v_and_b32 v105, 0xffff0000, v26
    v_lshlrev_b32 v106, 16, v27
    v_and_b32 v107, 0xffff0000, v27
    v_lshlrev_b32 v108, 16, v28
    v_and_b32 v109, 0xffff0000, v28
    v_lshlrev_b32 v110, 16, v29
    v_and_b32 v111, 0xffff0000, v29
    v_lshlrev_b32 v112, 16, v30
    v_and_b32 v113, 0xffff0000, v30
    v_lshlrev_b32 v114, 16, v31
    v_and_b32 v115, 0xffff0000, v31
    v_lshlrev_b32 v116, 16, v32
    v_and_b32 v117, 0xffff0000, v32
    v_lshlrev_b32 v118, 16, v33
    v_and_b32 v119, 0xffff0000, v33
    v_lshlrev_b32 v120, 16, v34
    v_and_b32 v121, 0xffff0000, v34
    v_lshlrev_b32 v122, 16, v35
    v_and_b32 v123, 0xffff0000, v35
    v_lshlrev_b32 v124, 16, v36
    v_and_b32 v125, 0xffff0000, v36
    v_lshlrev_b32 v126, 16, v37
    v_and_b32 v127, 0xffff0000, v37
    v_lshlrev_b32 v128, 16, v38
    v_and_b32 v129, 0xffff0000, v38
    v_lshlrev_b32 v130, 16, v39
    v_and_b32 v131, 0xffff0000, v39
    s_waitcnt lgkmcnt(0)
    v_mov_b32 v35, s41
    ds_read_u16 v24, v134 offset:0
    ds_read_u16 v228, v133 offset:64
    ds_read_u16 v25, v133 offset:128
    ds_read_u16 v229, v133 offset:192
    ds_read_u16 v26, v133 offset:256
    ds_read_u16 v230, v133 offset:320
    ds_read_u16 v27, v133 offset:384
    ds_read_u16 v231, v133 offset:448
    ds_read_u16 v28, v136 offset:0
    ds_read_u16 v232, v135 offset:384
    ds_read_u16 v29, v135 offset:320
    ds_read_u16 v233, v135 offset:256
    ds_read_u16 v30, v135 offset:192
    ds_read_u16 v234, v135 offset:128
    ds_read_u16 v31, v135 offset:64
    ds_read_u16 v235, v135 offset:0
    ds_read_u16 v36, v137 offset:0
    ds_read_u16 v236, v137 offset:64
    ds_read_u16 v37, v137 offset:128
    ds_read_u16 v237, v137 offset:192
    ds_read_u16 v38, v137 offset:256
    ds_read_u16 v238, v137 offset:320
    ds_read_u16 v39, v137 offset:384
    ds_read_u16 v239, v137 offset:448
    ds_read_u16 v40, v138 offset:448
    ds_read_u16 v240, v138 offset:384
    ds_read_u16 v41, v138 offset:320
    ds_read_u16 v241, v138 offset:256
    ds_read_u16 v42, v138 offset:192
    ds_read_u16 v242, v138 offset:128
    ds_read_u16 v43, v138 offset:64
    ds_read_u16 v243, v138 offset:0
    v_pk_add_f32 v[168:169], v[100:101], v[102:103]
    v_pk_add_f32 v[170:171], v[116:117], v[118:119]
    v_pk_add_f32 v[168:169], v[168:169], v[104:105]
    v_pk_add_f32 v[170:171], v[170:171], v[120:121]
    v_pk_add_f32 v[168:169], v[168:169], v[106:107]
    v_pk_add_f32 v[170:171], v[170:171], v[122:123]
    v_pk_add_f32 v[168:169], v[168:169], v[108:109]
    v_pk_add_f32 v[170:171], v[170:171], v[124:125]
    v_pk_add_f32 v[168:169], v[168:169], v[110:111]
    v_pk_add_f32 v[170:171], v[170:171], v[126:127]
    v_pk_add_f32 v[168:169], v[168:169], v[112:113]
    v_pk_add_f32 v[170:171], v[170:171], v[128:129]
    v_pk_add_f32 v[168:169], v[168:169], v[114:115]
    v_pk_add_f32 v[170:171], v[170:171], v[130:131]
    v_add_f32 v168, v168, v169
    v_add_f32 v170, v170, v171
    s_nop 1
    v_permlane32_swap_b32 v168, v170
    v_add_f32 v168, v168, v170
    s_nop 1
    v_add_f32_dpp v168, v168, v168 row_ror:8 row_mask:0xf bank_mask:0xf
    s_nop 1
    v_add_f32_dpp v168, v168, v168 row_ror:4 row_mask:0xf bank_mask:0xf
    s_nop 1
    v_add_f32_dpp v168, v168, v168 row_ror:2 row_mask:0xf bank_mask:0xf
    s_nop 1
    v_add_f32_dpp v168, v168, v168 row_ror:1 row_mask:0xf bank_mask:0xf
    v_mov_b32 v172, v168
    s_nop 1
    v_permlane16_swap_b32 v168, v172
    v_add_f32 v168, v168, v172
    v_mul_f32 v174, 0x3a800000, v168
    v_mov_b32 v172, v174
    v_mov_b32 v173, v174
    s_nop 1
    v_permlane32_swap_b32 v172, v173
    v_pk_add_f32 v[100:101], v[100:101], v[172:173] op_sel_hi:[1,0] neg_lo:[0,1] neg_hi:[0,1]
    v_pk_add_f32 v[116:117], v[116:117], v[172:173] op_sel:[0,1] op_sel_hi:[1,1] neg_lo:[0,1] neg_hi:[0,1]
    v_pk_add_f32 v[102:103], v[102:103], v[172:173] op_sel_hi:[1,0] neg_lo:[0,1] neg_hi:[0,1]
    v_pk_add_f32 v[118:119], v[118:119], v[172:173] op_sel:[0,1] op_sel_hi:[1,1] neg_lo:[0,1] neg_hi:[0,1]
    v_pk_add_f32 v[104:105], v[104:105], v[172:173] op_sel_hi:[1,0] neg_lo:[0,1] neg_hi:[0,1]
    v_pk_add_f32 v[120:121], v[120:121], v[172:173] op_sel:[0,1] op_sel_hi:[1,1] neg_lo:[0,1] neg_hi:[0,1]
    v_pk_add_f32 v[106:107], v[106:107], v[172:173] op_sel_hi:[1,0] neg_lo:[0,1] neg_hi:[0,1]
    v_pk_add_f32 v[122:123], v[122:123], v[172:173] op_sel:[0,1] op_sel_hi:[1,1] neg_lo:[0,1] neg_hi:[0,1]
    v_pk_add_f32 v[108:109], v[108:109], v[172:173] op_sel_hi:[1,0] neg_lo:[0,1] neg_hi:[0,1]
    v_pk_add_f32 v[124:125], v[124:125], v[172:173] op_sel:[0,1] op_sel_hi:[1,1] neg_lo:[0,1] neg_hi:[0,1]
    v_pk_add_f32 v[110:111], v[110:111], v[172:173] op_sel_hi:[1,0] neg_lo:[0,1] neg_hi:[0,1]
    v_pk_add_f32 v[126:127], v[126:127], v[172:173] op_sel:[0,1] op_sel_hi:[1,1] neg_lo:[0,1] neg_hi:[0,1]
    v_pk_add_f32 v[112:113], v[112:113], v[172:173] op_sel_hi:[1,0] neg_lo:[0,1] neg_hi:[0,1]
    v_pk_add_f32 v[128:129], v[128:129], v[172:173] op_sel:[0,1] op_sel_hi:[1,1] neg_lo:[0,1] neg_hi:[0,1]
    v_pk_add_f32 v[114:115], v[114:115], v[172:173] op_sel_hi:[1,0] neg_lo:[0,1] neg_hi:[0,1]
    v_pk_add_f32 v[130:131], v[130:131], v[172:173] op_sel:[0,1] op_sel_hi:[1,1] neg_lo:[0,1] neg_hi:[0,1]
    v_pk_mul_f32 v[168:169], v[100:101], v[100:101]
    v_pk_mul_f32 v[170:171], v[116:117], v[116:117]
    v_pk_fma_f32 v[168:169], v[102:103], v[102:103], v[168:169]
    v_pk_fma_f32 v[170:171], v[118:119], v[118:119], v[170:171]
    v_pk_fma_f32 v[168:169], v[104:105], v[104:105], v[168:169]
    v_pk_fma_f32 v[170:171], v[120:121], v[120:121], v[170:171]
    v_pk_fma_f32 v[168:169], v[106:107], v[106:107], v[168:169]
    v_pk_fma_f32 v[170:171], v[122:123], v[122:123], v[170:171]
    v_pk_fma_f32 v[168:169], v[108:109], v[108:109], v[168:169]
    v_pk_fma_f32 v[170:171], v[124:125], v[124:125], v[170:171]
    v_pk_fma_f32 v[168:169], v[110:111], v[110:111], v[168:169]
    v_pk_fma_f32 v[170:171], v[126:127], v[126:127], v[170:171]
    v_pk_fma_f32 v[168:169], v[112:113], v[112:113], v[168:169]
    v_pk_fma_f32 v[170:171], v[128:129], v[128:129], v[170:171]
    v_pk_fma_f32 v[168:169], v[114:115], v[114:115], v[168:169]
    v_pk_fma_f32 v[170:171], v[130:131], v[130:131], v[170:171]
    v_add_f32 v168, v168, v169
    v_add_f32 v170, v170, v171
    s_waitcnt lgkmcnt(0)
    v_lshl_or_b32 v24, v228, 16, v24
    v_lshl_or_b32 v25, v229, 16, v25
    v_lshl_or_b32 v26, v230, 16, v26
    v_lshl_or_b32 v27, v231, 16, v27
    buffer_store_dwordx4 v[24:27], v246, s[4:7], s51 offen offset:0
    v_lshl_or_b32 v28, v232, 16, v28
    v_lshl_or_b32 v29, v233, 16, v29
    v_lshl_or_b32 v30, v234, 16, v30
    v_lshl_or_b32 v31, v235, 16, v31
    buffer_store_dwordx4 v[28:31], v246, s[4:7], s51 offen offset:128
    v_lshl_or_b32 v36, v236, 16, v36
    v_lshl_or_b32 v37, v237, 16, v37
    v_lshl_or_b32 v38, v238, 16, v38
    v_lshl_or_b32 v39, v239, 16, v39
    buffer_store_dwordx4 v[36:39], v246, s[4:7], s53 offen offset:0
    v_lshl_or_b32 v40, v240, 16, v40
    v_lshl_or_b32 v41, v241, 16, v41
    v_lshl_or_b32 v42, v242, 16, v42
    v_lshl_or_b32 v43, v243, 16, v43
    buffer_store_dwordx4 v[40:43], v246, s[4:7], s53 offen offset:128
    v_permlane32_swap_b32 v168, v170
    v_add_f32 v168, v168, v170
    s_nop 1
    v_add_f32_dpp v168, v168, v168 row_ror:8 row_mask:0xf bank_mask:0xf
    s_nop 1
    v_add_f32_dpp v168, v168, v168 row_ror:4 row_mask:0xf bank_mask:0xf
    s_nop 1
    v_add_f32_dpp v168, v168, v168 row_ror:2 row_mask:0xf bank_mask:0xf
    s_nop 1
    v_add_f32_dpp v168, v168, v168 row_ror:1 row_mask:0xf bank_mask:0xf
    v_mov_b32 v172, v168
    s_nop 1
    v_permlane16_swap_b32 v168, v172
    v_add_f32 v168, v168, v172
    v_mov_b32 v172, 0x3727c5ac
    v_fmac_f32 v172, 0x3a800000, v168
    v_rsq_f32 v168, v172
    s_mov_b32 s46, 0xaaaaaaaa
    s_mov_b32 s47, 0xaaaaaaaa
    v_mul_f32 v169, v174, v168
    v_cndmask_b32 v168, v168, v169, s[46:47]
    v_mov_b32 v169, v168
    s_nop 1
    v_permlane32_swap_b32 v168, v169
    v_cndmask_b32 v32, v168, v169, s[44:45]
    v_cndmask_b32 v44, v168, v169, s[44:45]
    v_add3_u32 v33, v24, v25, v26
    v_add3_u32 v45, v36, v37, v38
    v_add3_u32 v34, v28, v29, v30
    v_add3_u32 v228, v40, v41, v42
    v_add3_u32 v33, v33, v27, 0
    v_add3_u32 v45, v45, v39, 0
    v_add3_u32 v34, v34, v31, v32
    v_add3_u32 v228, v228, v43, v44
    v_alignbit_b32 v34, v34, v34, 19
    v_alignbit_b32 v228, v228, v228, 19
    v_add_u32 v33, v33, v34
    v_add_u32 v45, v45, v228
    s_nop 1
    v_add_u32_dpp v33, v33, v33 quad_perm:[1,0,3,2] row_mask:0xf bank_mask:0xf
    v_add_u32_dpp v45, v45, v45 quad_perm:[1,0,3,2] row_mask:0xf bank_mask:0xf
    s_nop 1
    v_add_u32_dpp v33, v33, v33 quad_perm:[2,3,0,1] row_mask:0xf bank_mask:0xf
    v_add_u32_dpp v45, v45, v45 quad_perm:[2,3,0,1] row_mask:0xf bank_mask:0xf
    s_nop 1
    v_add_u32_dpp v33, v33, v33 row_half_mirror row_mask:0xf bank_mask:0xf
    v_add_u32_dpp v45, v45, v45 row_half_mirror row_mask:0xf bank_mask:0xf
    v_add_u32 v33, s41, v33
    v_add_u32 v45, s41, v45
    s_mov_b64 exec, 0xff
    buffer_store_dword v32, v47, s[4:7], s51 offen
    s_mov_b32 exec_lo, 0x01010101
    s_mov_b32 exec_hi, 0x01010101
    buffer_store_dword v33, v46, s[4:7], s51 offen offset:0
    s_mov_b64 exec, -1
    s_mov_b32 exec_lo, 0x01010101
    s_mov_b32 exec_hi, 0x01010101
    buffer_store_dword v45, v46, s[4:7], s51 offen offset:2048
    s_mov_b64 exec, -1
    s_mov_b32 s26, 655360
    buffer_store_dwordx4 v[20:23], v5, s[4:7], s26 offen sc1
    buffer_store_dwordx4 v[20:23], v5, s[4:7], s26 offen offset:512 sc1
    s_waitcnt vmcnt(10)
    s_barrier
    s_cmp_lg_u32 s19, 0
    s_cbranch_scc1 NOFLAG
    s_lshl_b32 s26, s17, 4
    s_add_u32 s26, s26, s50
    v_mov_b32 v16, 393216
    s_mov_b64 exec, 1
    buffer_store_dword v35, v16, s[4:7], s26 offen sc1
    s_mov_b64 exec, -1
NOFLAG:
    buffer_load_dwordx2 v[248:249], v245, s[4:7], s95 offen sc1
    buffer_load_dwordx4 v[204:207], v202, s[4:7], s55 offen offset:0
    buffer_load_dwordx4 v[216:219], v202, s[4:7], s55 offen offset:64
    buffer_load_dwordx4 v[208:211], v202, s[4:7], s55 offen offset:128
    buffer_load_dwordx4 v[220:223], v202, s[4:7], s55 offen offset:192
    s_mul_i32 s27, s17, 16384
    s_sub_u32 s27, s55, s27
    buffer_load_dword v213, v214, s[4:7], s27 offen
    buffer_load_dword v212, v215, s[4:7], s27 offen offset:0
    buffer_load_dword v224, v215, s[4:7], s27 offen offset:16
    s_branch EHGEN
EH_DONE:
    v_lshlrev_b32 v16, 21, v3
    v_lshl_add_u32 v16, v2, 4, v16
    s_lshl_b32 s93, s19, 23
    s_add_u32 s93, s93, 393216
    s_mov_b32 s24, 20000
    s_waitcnt vmcnt(0)
    v_cmp_ne_u32 vcc, s41, v248
    s_cbranch_vccnz XCHK
XOK:
    v_cmp_ne_u32 vcc, s94, v249
    s_mov_b32 s92, 1
    s_mov_b32 s3, 15
    s_cbranch_vccnz HSLOW
    s_branch HCHK
HPOLL:
    buffer_load_dwordx4 v[204:207], v202, s[4:7], s55 offen offset:0 sc1
    buffer_load_dwordx4 v[216:219], v202, s[4:7], s55 offen offset:64 sc1
    buffer_load_dwordx4 v[208:211], v202, s[4:7], s55 offen offset:128 sc1
    buffer_load_dwordx4 v[220:223], v202, s[4:7], s55 offen offset:192 sc1
    s_mul_i32 s27, s17, 16384
    s_sub_u32 s27, s55, s27
    buffer_load_dword v213, v214, s[4:7], s27 offen sc1
    buffer_load_dword v212, v215, s[4:7], s27 offen offset:0 sc1
    buffer_load_dword v224, v215, s[4:7], s27 offen offset:16 sc1
HCHK:
    s_waitcnt vmcnt(0)
    v_add3_u32 v232, v204, v205, v206
    v_add3_u32 v233, v216, v217, v218
    v_add3_u32 v226, v208, v209, v210
    v_add3_u32 v227, v220, v221, v222
    v_add3_u32 v232, v232, v207, 0
    v_add3_u32 v233, v233, v219, 0
    v_add3_u32 v226, v226, v211, v212
    v_add3_u32 v227, v227, v223, v224
    v_alignbit_b32 v226, v226, v226, 19
    v_alignbit_b32 v227, v227, v227, 19
    v_add_u32 v232, v232, v226
    v_add_u32 v233, v233, v227
    v_add_u32 v232, v232, v233
    v_mov_b32 v233, v232
    s_nop 1
    v_permlane32_swap_b32 v232, v233
    s_nop 1
    v_add_u32 v232, v232, v233
    v_mov_b32 v233, v232
    s_nop 1
    v_permlane16_swap_b32 v232, v233
    s_nop 1
    v_add3_u32 v232, v232, v233, s41
    v_mov_b32 v233, v225
    v_cmp_ne_u32 vcc, v213, v232
    v_cmp_ne_u32 s[44:45], v225, v233
    s_or_b64 s[44:45], s[44:45], vcc
    s_cbranch_scc0 HGOT
    s_sub_u32 s24, s24, 1
    s_cbranch_scc0 HPOLL
    s_or_b32 s25, s25, 8
HGOT:
    buffer_load_dword v17, v16, s[4:7], s93 offen sc1
    v_mov_b32 v156, v212
    v_mov_b32 v157, v212
    v_mov_b32 v158, v224
    v_mov_b32 v159, v224
    v_lshlrev_b32 v24, 16, v204
    v_and_b32 v25, 0xffff0000, v204
    v_lshlrev_b32 v26, 16, v205
    v_and_b32 v27, 0xffff0000, v205
    v_lshlrev_b32 v28, 16, v206
    v_and_b32 v29, 0xffff0000, v206
    v_lshlrev_b32 v30, 16, v207
    v_and_b32 v31, 0xffff0000, v207
    v_permlane16_swap_b32 v156, v157
    v_permlane16_swap_b32 v158, v159
    v_lshlrev_b32 v32, 16, v216
    v_and_b32 v33, 0xffff0000, v216
    v_lshlrev_b32 v34, 16, v217
    v_and_b32 v35, 0xffff0000, v217
    v_lshlrev_b32 v36, 16, v218
    v_and_b32 v37, 0xffff0000, v218
    v_lshlrev_b32 v38, 16, v219
    v_and_b32 v39, 0xffff0000, v219
    v_lshlrev_b32 v40, 16, v208
    v_and_b32 v41, 0xffff0000, v208
    v_lshlrev_b32 v42, 16, v209
    v_and_b32 v43, 0xffff0000, v209
    v_lshlrev_b32 v44, 16, v210
    v_and_b32 v45, 0xffff0000, v210
    v_lshlrev_b32 v46, 16, v211
    v_and_b32 v47, 0xffff0000, v211
    v_lshlrev_b32 v48, 16, v220
    v_and_b32 v49, 0xffff0000, v220
    v_lshlrev_b32 v50, 16, v221
    v_and_b32 v51, 0xffff0000, v221
    v_lshlrev_b32 v52, 16, v222
    v_and_b32 v53, 0xffff0000, v222
    v_lshlrev_b32 v54, 16, v223
    v_and_b32 v55, 0xffff0000, v223
LOOP:
    v_cndmask_b32 v160, v158, v156, s[42:43]
    v_cndmask_b32 v161, v156, v158, s[42:43]
    v_cndmask_b32 v162, v159, v157, s[42:43]
    v_cndmask_b32 v163, v157, v159, s[42:43]
    v_add_f32 v162, v162, v157
    v_add_f32 v163, v163, v159
    v_pk_fma_f32 v[164:165], v[24:25], v[156:157], v[162:163] op_sel_hi:[1,0,0] neg_lo:[0,0,1] neg_hi:[0,0,1]
    v_pk_fma_f32 v[172:173], v[32:33], v[158:159], v[162:163] op_sel:[0,0,1] op_sel_hi:[1,0,1] neg_lo:[0,0,1] neg_hi:[0,0,1]
    v_pk_fma_f32 v[166:167], v[26:27], v[156:157], v[162:163] op_sel_hi:[1,0,0] neg_lo:[0,0,1] neg_hi:[0,0,1]
    v_pk_fma_f32 v[174:175], v[34:35], v[158:159], v[162:163] op_sel:[0,0,1] op_sel_hi:[1,0,1] neg_lo:[0,0,1] neg_hi:[0,0,1]
    v_pk_fma_f32 v[168:169], v[28:29], v[156:157], v[162:163] op_sel_hi:[1,0,0] neg_lo:[0,0,1] neg_hi:[0,0,1]
    v_pk_fma_f32 v[176:177], v[36:37], v[158:159], v[162:163] op_sel:[0,0,1] op_sel_hi:[1,0,1] neg_lo:[0,0,1] neg_hi:[0,0,1]
    v_pk_fma_f32 v[170:171], v[30:31], v[156:157], v[162:163] op_sel_hi:[1,0,0] neg_lo:[0,0,1] neg_hi:[0,0,1]
    v_pk_fma_f32 v[178:179], v[38:39], v[158:159], v[162:163] op_sel:[0,0,1] op_sel_hi:[1,0,1] neg_lo:[0,0,1] neg_hi:[0,0,1]
    v_pk_fma_f32 v[164:165], v[48:49], v[160:161], v[164:165] op_sel_hi:[1,0,1]
    v_pk_fma_f32 v[172:173], v[40:41], v[160:161], v[172:173] op_sel:[0,1,0] op_sel_hi:[1,1,1]
    v_pk_fma_f32 v[166:167], v[50:51], v[160:161], v[166:167] op_sel_hi:[1,0,1]
    v_pk_fma_f32 v[174:175], v[42:43], v[160:161], v[174:175] op_sel:[0,1,0] op_sel_hi:[1,1,1]
    v_pk_fma_f32 v[168:169], v[52:53], v[160:161], v[168:169] op_sel_hi:[1,0,1]
    v_pk_fma_f32 v[176:177], v[44:45], v[160:161], v[176:177] op_sel:[0,1,0] op_sel_hi:[1,1,1]
    v_pk_fma_f32 v[170:171], v[54:55], v[160:161], v[170:171] op_sel_hi:[1,0,1]
    v_pk_fma_f32 v[178:179], v[46:47], v[160:161], v[178:179] op_sel:[0,1,0] op_sel_hi:[1,1,1]
    v_cvt_pk_f16_f32 v180, v164, v165
    v_cvt_pk_f16_f32 v181, v166, v167
    v_cvt_pk_f16_f32 v182, v168, v169
    v_cvt_pk_f16_f32 v183, v170, v171
    v_cvt_pk_f16_f32 v184, v172, v173
    v_cvt_pk_f16_f32 v185, v174, v175
    v_cvt_pk_f16_f32 v186, v176, v177
    v_cvt_pk_f16_f32 v187, v178, v179
    s_cmp_eq_u32 s17, 0
    s_cbranch_scc1 COL0
    v_mfma_f32_16x16x32_f16 v[196:199], v[180:183], v[56:59], 0
    v_mfma_f32_16x16x32_f16 v[200:203], v[180:183], v[60:63], 0
    v_mfma_f32_16x16x32_f16 v[204:207], v[184:187], v[64:67], 0
    v_mfma_f32_16x16x32_f16 v[208:211], v[184:187], v[68:71], 0
COL_DONE:
    s_nop 4
    v_cvt_pk_f16_f32 v212, v196, v197
    v_cvt_pk_f16_f32 v213, v198, v199
    ds_write_b64 v10, v[212:213] offset:0
    v_cvt_pk_f16_f32 v214, v200, v201
    v_cvt_pk_f16_f32 v215, v202, v203
    ds_write_b64 v10, v[214:215] offset:1024
    v_cvt_pk_f16_f32 v216, v204, v205
    v_cvt_pk_f16_f32 v217, v206, v207
    ds_write_b64 v11, v[216:217] offset:0
    v_cvt_pk_f16_f32 v218, v208, v209
    v_cvt_pk_f16_f32 v219, v210, v211
    ds_write_b64 v11, v[218:219] offset:1024
    s_waitcnt lgkmcnt(0)
    s_barrier
    ds_read_b128 v[164:167], v12 offset:0
    ds_read_b128 v[168:171], v12 offset:2048
    ds_read_b128 v[172:175], v12 offset:4096
    ds_read_b128 v[176:179], v12 offset:6144
    s_waitcnt lgkmcnt(3)
    v_mfma_f32_16x16x32_f16 v[180:183], v[88:91], v[164:167], 0
    s_waitcnt lgkmcnt(2)
    v_mfma_f32_16x16x32_f16 v[184:187], v[92:95], v[168:171], 0
    s_waitcnt lgkmcnt(1)
    v_mfma_f32_16x16x32_f16 v[188:191], v[96:99], v[172:175], 0
    s_waitcnt lgkmcnt(0)
    v_mfma_f32_16x16x32_f16 v[192:195], v[92:95], v[176:179], 0
    s_nop 1
    v_cvt_pk_f16_f32 v220, v180, v181
    s_nop 0
    v_cvt_pk_f16_f32 v221, v184, v185
    s_nop 0
    v_cvt_pk_f16_f32 v222, v188, v189
    s_nop 0
    v_cvt_pk_f16_f32 v223, v192, v193
    buffer_store_dwordx4 v[220:223], v5, s[4:7], s21 offen offset:0 sc1
    v_cvt_pk_f16_f32 v224, v182, v183
    v_cvt_pk_f16_f32 v225, v186, v187
    v_cvt_pk_f16_f32 v226, v190, v191
    v_cvt_pk_f16_f32 v227, v194, v195
    buffer_store_dwordx4 v[224:227], v5, s[4:7], s21 offen offset:512 sc1
    s_cmp_eq_u32 s20, 0
    s_cbranch_scc1 FLAGS
CLR_DONE:
    s_mov_b32 s24, 20000
    s_waitcnt vmcnt(0)
XPOLL:
    buffer_load_dwordx4 v[164:167], v4, s[4:7], s21 offen sc1
    buffer_load_dwordx4 v[168:171], v4, s[4:7], s22 offen sc1
XP1:
    s_cmp_eq_u32 s3, 8
    s_cbranch_scc1 XT3
XGO3:
    s_waitcnt vmcnt(0)
    v_max3_u32 v232, v164, v165, v166
    v_max3_u32 v233, v167, v168, v169
    v_max3_u32 v232, v232, v170, v171
    v_max_u32 v232, v232, v233
    v_cmp_eq_u32 vcc, -1, v232
    s_sub_u32 s24, s24, 1
    s_cbranch_vccz DONE_1
    s_cbranch_scc0 XPOLL
    s_or_b32 s25, s25, 1
DONE_1:
    ds_write_b128 v13, v[164:167]
    ds_write_b128 v13, v[168:171] offset:1024
    s_cmp_lt_u32 s20, 3
    s_cbranch_scc1 XTRA
XGO:
    s_waitcnt lgkmcnt(0)
    s_barrier
    ds_read_b128 v[172:175], v14 offset:0
    ds_read_b128 v[176:179], v14 offset:256
    ds_read_b128 v[180:183], v14 offset:2048
    ds_read_b128 v[184:187], v14 offset:2304
    ds_read_b128 v[188:191], v14 offset:4096
    ds_read_b128 v[192:195], v14 offset:4352
    ds_read_b128 v[196:199], v14 offset:6144
    ds_read_b128 v[200:203], v14 offset:6400
    s_waitcnt lgkmcnt(7)
    v_mfma_f32_16x16x32_f16 v[204:207], v[172:175], v[100:103], 0
    v_mfma_f32_16x16x32_f16 v[212:215], v[172:175], v[116:119], 0
    s_waitcnt lgkmcnt(6)
    v_mfma_f32_16x16x32_f16 v[208:211], v[176:179], v[100:103], 0
    v_mfma_f32_16x16x32_f16 v[216:219], v[176:179], v[116:119], 0
    s_waitcnt lgkmcnt(5)
    v_mfma_f32_16x16x32_f16 v[204:207], v[180:183], v[104:107], v[204:207]
    v_mfma_f32_16x16x32_f16 v[212:215], v[180:183], v[120:123], v[212:215]
    s_waitcnt lgkmcnt(4)
    v_mfma_f32_16x16x32_f16 v[208:211], v[184:187], v[104:107], v[208:211]
    v_mfma_f32_16x16x32_f16 v[216:219], v[184:187], v[120:123], v[216:219]
    s_waitcnt lgkmcnt(3)
    v_mfma_f32_16x16x32_f16 v[204:207], v[188:191], v[108:111], v[204:207]
    v_mfma_f32_16x16x32_f16 v[212:215], v[188:191], v[124:127], v[212:215]
    s_waitcnt lgkmcnt(2)
    v_mfma_f32_16x16x32_f16 v[208:211], v[192:195], v[108:111], v[208:211]
    v_mfma_f32_16x16x32_f16 v[216:219], v[192:195], v[124:127], v[216:219]
    s_waitcnt lgkmcnt(1)
    v_mfma_f32_16x16x32_f16 v[204:207], v[196:199], v[112:115], v[204:207]
    v_mfma_f32_16x16x32_f16 v[212:215], v[196:199], v[128:131], v[212:215]
    s_waitcnt lgkmcnt(0)
    v_mfma_f32_16x16x32_f16 v[208:211], v[200:203], v[112:115], v[208:211]
    v_mfma_f32_16x16x32_f16 v[216:219], v[200:203], v[128:131], v[216:219]
    s_nop 3
    v_cvt_pk_f16_f32 v220, v204, v205
    v_cvt_pk_f16_f32 v221, v206, v207
    s_nop 0
    v_cvt_pk_f16_f32 v222, v208, v209
    v_cvt_pk_f16_f32 v223, v210, v211
    v_cvt_pk_f16_f32 v224, v212, v213
    v_cvt_pk_f16_f32 v225, v214, v215
    v_cvt_pk_f16_f32 v226, v216, v217
    v_cvt_pk_f16_f32 v227, v218, v219
    s_cmp_eq_u32 s30, 0
    s_cbranch_scc1 HSPEC
    v_mfma_f32_16x16x32_f16 v[164:167], v[132:135], v[220:223], 0
    v_mfma_f32_16x16x32_f16 v[168:171], v[136:139], v[220:223], 0
    v_mfma_f32_16x16x32_f16 v[172:175], v[140:143], v[224:227], 0
    v_mfma_f32_16x16x32_f16 v[176:179], v[144:147], v[224:227], 0
H_DONE:
    s_nop 6
    v_pk_add_f32 v[180:181], v[164:165], v[172:173] neg_lo:[0,1] neg_hi:[0,1]
    v_pk_add_f32 v[188:189], v[164:165], v[172:173]
    v_pk_add_f32 v[182:183], v[166:167], v[174:175] neg_lo:[0,1] neg_hi:[0,1]
    v_pk_add_f32 v[190:191], v[166:167], v[174:175]
    v_pk_add_f32 v[184:185], v[168:169], v[176:177] neg_lo:[0,1] neg_hi:[0,1]
    v_pk_add_f32 v[192:193], v[168:169], v[176:177]
    v_pk_add_f32 v[186:187], v[170:171], v[178:179] neg_lo:[0,1] neg_hi:[0,1]
    v_pk_add_f32 v[194:195], v[170:171], v[178:179]
    v_pk_add_f32 v[24:25], v[24:25], v[180:181]
    v_pk_fma_f32 v[32:33], v[188:189], v[148:149], v[32:33]
    v_pk_fma_f32 v[40:41], v[188:189], v[150:151], v[40:41]
    v_pk_fma_f32 v[48:49], v[180:181], v[152:153], v[48:49]
    v_pk_add_f32 v[26:27], v[26:27], v[182:183]
    v_pk_add_f32 v[34:35], v[34:35], v[190:191]
    v_pk_add_f32 v[42:43], v[42:43], v[190:191]
    v_pk_add_f32 v[50:51], v[50:51], v[182:183]
    v_pk_add_f32 v[28:29], v[28:29], v[184:185]
    v_pk_add_f32 v[36:37], v[36:37], v[192:193]
    v_pk_add_f32 v[44:45], v[44:45], v[192:193]
    v_pk_add_f32 v[52:53], v[52:53], v[184:185]
    v_pk_add_f32 v[30:31], v[30:31], v[186:187]
    v_pk_add_f32 v[38:39], v[38:39], v[194:195]
    v_pk_add_f32 v[46:47], v[46:47], v[194:195]
    v_pk_add_f32 v[54:55], v[54:55], v[186:187]
    s_cmp_eq_u32 s20, 3
    s_cbranch_scc1 FINAL
    v_pk_add_f32 v[164:165], v[24:25], v[26:27]
    v_pk_mul_f32 v[172:173], v[24:25], v[24:25]
    v_pk_add_f32 v[166:167], v[32:33], v[34:35]
    v_pk_mul_f32 v[174:175], v[32:33], v[32:33]
    v_pk_add_f32 v[168:169], v[40:41], v[42:43]
    v_pk_mul_f32 v[176:177], v[40:41], v[40:41]
    v_pk_add_f32 v[170:171], v[48:49], v[50:51]
    v_pk_mul_f32 v[178:179], v[48:49], v[48:49]
    v_pk_fma_f32 v[172:173], v[26:27], v[26:27], v[172:173]
    v_pk_fma_f32 v[174:175], v[34:35], v[34:35], v[174:175]
    v_pk_fma_f32 v[176:177], v[42:43], v[42:43], v[176:177]
    v_pk_fma_f32 v[178:179], v[50:51], v[50:51], v[178:179]
    v_pk_add_f32 v[164:165], v[164:165], v[28:29]
    v_pk_fma_f32 v[172:173], v[28:29], v[28:29], v[172:173]
    v_pk_add_f32 v[166:167], v[166:167], v[36:37]
    v_pk_fma_f32 v[174:175], v[36:37], v[36:37], v[174:175]
    v_pk_add_f32 v[168:169], v[168:169], v[44:45]
    v_pk_fma_f32 v[176:177], v[44:45], v[44:45], v[176:177]
    v_pk_add_f32 v[170:171], v[170:171], v[52:53]
    v_pk_fma_f32 v[178:179], v[52:53], v[52:53], v[178:179]
    v_pk_add_f32 v[164:165], v[164:165], v[30:31]
    v_pk_fma_f32 v[172:173], v[30:31], v[30:31], v[172:173]
    v_pk_add_f32 v[166:167], v[166:167], v[38:39]
    v_pk_fma_f32 v[174:175], v[38:39], v[38:39], v[174:175]
    v_pk_add_f32 v[168:169], v[168:169], v[46:47]
    v_pk_fma_f32 v[176:177], v[46:47], v[46:47], v[176:177]
    v_pk_add_f32 v[170:171], v[170:171], v[54:55]
    v_pk_fma_f32 v[178:179], v[54:55], v[54:55], v[178:179]
    s_cmp_lg_u32 s30, 0
    s_cbranch_scc1 NOSWAP
    s_mov_b64 exec, s[42:43]
    v_swap_b32 v168, v170
    v_swap_b32 v169, v171
    v_swap_b32 v176, v178
    v_swap_b32 v177, v179
    s_mov_b64 exec, -1
NOSWAP:
    v_pk_add_f32 v[164:165], v[164:165], v[168:169]
    v_pk_add_f32 v[166:167], v[166:167], v[170:171]
    v_pk_add_f32 v[172:173], v[172:173], v[176:177]
    v_pk_add_f32 v[174:175], v[174:175], v[178:179]
    v_add_f32 v164, v164, v165
    v_add_f32 v166, v166, v167
    v_add_f32 v172, v172, v173
    v_add_f32 v174, v174, v175
    v_permlane32_swap_b32 v164, v166
    s_nop 0
    v_permlane32_swap_b32 v172, v174
    v_add_f32 v164, v164, v166
    v_add_f32 v172, v172, v174
    s_nop 1
    v_permlane16_swap_b32 v164, v172
    s_cmp_eq_u32 s92, 0
    s_mov_b32 s24, 20000
    v_add_f32 v164, v164, v172
    s_cbranch_scc1 SSLOW
    buffer_store_dword v164, v6, s[4:7], s23 offen
    s_waitcnt vmcnt(0)
SPOLL:
    buffer_load_dwordx4 v[180:183], v7, s[4:7], s23 offen offset:0 sc1
    buffer_load_dwordx4 v[184:187], v7, s[4:7], s23 offen offset:1024 sc1
    buffer_load_dwordx4 v[188:191], v7, s[4:7], s23 offen offset:2048 sc1
    buffer_load_dwordx4 v[192:195], v7, s[4:7], s23 offen offset:3072 sc1
    s_waitcnt vmcnt(0)
    v_max3_u32 v232, v180, v181, v182
    v_max3_u32 v233, v183, v184, v185
    v_max3_u32 v232, v232, v186, v187
    v_max3_u32 v233, v233, v188, v189
    v_max3_u32 v232, v232, v190, v191
    v_max3_u32 v233, v233, v192, v193
    v_max3_u32 v232, v232, v194, v195
    v_max_u32 v232, v232, v233
    v_cmp_eq_u32 vcc, -1, v232
    s_sub_u32 s24, s24, 1
    s_cbranch_vccz DONE_2
    s_cbranch_scc0 SPOLL
    s_or_b32 s25, s25, 2
DONE_2:
    v_pk_add_f32 v[180:181], v[180:181], v[184:185]
    v_pk_add_f32 v[182:183], v[182:183], v[186:187]
    v_pk_add_f32 v[188:189], v[188:189], v[192:193]
    v_pk_add_f32 v[190:191], v[190:191], v[194:195]
    v_pk_add_f32 v[180:181], v[180:181], v[188:189]
    v_pk_add_f32 v[182:183], v[182:183], v[190:191]
    s_nop 1
    v_permlane32_swap_b32 v180, v182
    v_permlane32_swap_b32 v181, v183
    v_pk_add_f32 v[180:181], v[180:181], v[182:183]
    v_mov_b64 v[184:185], v[180:181]
    s_nop 1
    v_permlane16_swap_b32 v180, v184
    v_permlane16_swap_b32 v181, v185
    v_pk_add_f32 v[180:181], v[180:181], v[184:185]
    v_mul_f32 v180, 0x3a800000, v180
    v_mul_f32 v181, 0x3a800000, v181
    v_fma_f32 v181, -v180, v180, v181
    v_max_f32 v181, 0, v181
    v_add_f32 v181, 0x3727c5ac, v181
    v_rsq_f32 v156, v181
    s_nop 0
    v_mul_f32 v157, v180, v156
    v_mov_b32 v158, v156
    v_mov_b32 v159, v157
    s_nop 0
    v_permlane32_swap_b32 v156, v158
    v_permlane32_swap_b32 v157, v159
    s_add_u32 s20, s20, 1
    s_add_u32 s21, s21, 131072
    s_add_u32 s22, s22, 131072
    s_add_u32 s23, s23, 16384
    s_branch LOOP
FINAL:
    s_cmp_eq_u32 s92, 0
    s_cselect_b32 s29, 1048576, 0
    s_cbranch_scc1 FSLOW
    v_cvt_pk_bf16_f32 v164, v24, v25
    v_cvt_pk_bf16_f32 v165, v26, v27
    v_cvt_pk_bf16_f32 v166, v28, v29
    v_cvt_pk_bf16_f32 v167, v30, v31
    buffer_store_dwordx4 v[164:167], v8, s[4:7], s29 offen offset:0
    v_cvt_pk_bf16_f32 v168, v32, v33
    v_cvt_pk_bf16_f32 v169, v34, v35
    v_cvt_pk_bf16_f32 v170, v36, v37
    v_cvt_pk_bf16_f32 v171, v38, v39
    buffer_store_dwordx4 v[168:171], v8, s[4:7], s29 offen offset:256
    v_cvt_pk_bf16_f32 v172, v40, v41
    v_cvt_pk_bf16_f32 v173, v42, v43
    v_cvt_pk_bf16_f32 v174, v44, v45
    v_cvt_pk_bf16_f32 v175, v46, v47
    buffer_store_dwordx4 v[172:175], v8, s[4:7], s29 offen offset:512
    v_cvt_pk_bf16_f32 v176, v48, v49
    v_cvt_pk_bf16_f32 v177, v50, v51
    v_cvt_pk_bf16_f32 v178, v52, v53
    v_cvt_pk_bf16_f32 v179, v54, v55
    buffer_store_dwordx4 v[176:179], v8, s[4:7], s29 offen offset:768
F_DONE:
    s_mov_b32 s24, 20000
    s_waitcnt vmcnt(0)
FPOLL:
    buffer_load_dwordx4 v[180:183], v9, s[4:7], s29 offen sc1
    buffer_load_dwordx4 v[184:187], v9, s[4:7], s29 offen offset:256 sc1
    buffer_load_dwordx4 v[188:191], v9, s[4:7], s39 offen sc1
    buffer_load_dwordx4 v[192:195], v9, s[4:7], s40 offen sc1
    s_waitcnt vmcnt(0)
    v_max3_u32 v232, v180, v181, v182
    v_max3_u32 v233, v183, v184, v185
    v_max3_u32 v232, v232, v186, v187
    v_max3_u32 v233, v233, v188, v189
    v_max3_u32 v232, v232, v190, v191
    v_max3_u32 v233, v233, v192, v193
    v_max3_u32 v232, v232, v194, v195
    v_max_u32 v232, v232, v233
    v_cmp_eq_u32 vcc, -1, v232
    s_sub_u32 s24, s24, 1
    s_cbranch_vccz DONE_3
    s_cbranch_scc0 FPOLL
    s_or_b32 s25, s25, 4
DONE_3:
    ds_write_b16 v59, v180 offset:0
    ds_write_b16_d16_hi v57, v180 offset:64
    ds_write_b16 v57, v181 offset:128
    ds_write_b16_d16_hi v57, v181 offset:192
    ds_write_b16 v57, v182 offset:256
    ds_write_b16_d16_hi v57, v182 offset:320
    ds_write_b16 v57, v183 offset:384
    ds_write_b16_d16_hi v57, v183 offset:448
    ds_write_b16 v57, v184 offset:2176
    ds_write_b16_d16_hi v57, v184 offset:2240
    ds_write_b16 v57, v185 offset:2304
    ds_write_b16_d16_hi v57, v185 offset:2368
    ds_write_b16 v57, v186 offset:2432
    ds_write_b16_d16_hi v57, v186 offset:2496
    ds_write_b16 v57, v187 offset:2560
    ds_write_b16_d16_hi v57, v187 offset:2624
    ds_write_b16 v60, v188 offset:0
    ds_write_b16_d16_hi v58, v188 offset:384
    ds_write_b16 v58, v189 offset:320
    ds_write_b16_d16_hi v58, v189 offset:256
    ds_write_b16 v58, v190 offset:192
    ds_write_b16_d16_hi v58, v190 offset:128
    ds_write_b16 v58, v191 offset:64
    ds_write_b16_d16_hi v58, v191 offset:0
    ds_write_b16 v61, v192 offset:2176
    ds_write_b16_d16_hi v58, v192 offset:2560
    ds_write_b16 v58, v193 offset:2496
    ds_write_b16_d16_hi v58, v193 offset:2432
    ds_write_b16 v58, v194 offset:2368
    ds_write_b16_d16_hi v58, v194 offset:2304
    ds_write_b16 v58, v195 offset:2240
    ds_write_b16_d16_hi v58, v195 offset:2176
    s_waitcnt lgkmcnt(0)
    ds_read_b128 v[164:167], v56 offset:0
    ds_read_b128 v[168:171], v56 offset:1088
    ds_read_b128 v[172:175], v56 offset:2176
    ds_read_b128 v[176:179], v56 offset:3264
    s_waitcnt lgkmcnt(3)
    buffer_store_dwordx4 v[164:167], v62, s[8:11], s36 offen offset:0
    s_waitcnt lgkmcnt(2)
    buffer_store_dwordx4 v[168:171], v62, s[8:11], s36 offen offset:1024
    s_waitcnt lgkmcnt(1)
    buffer_store_dwordx4 v[172:175], v62, s[8:11], s37 offen offset:0
    s_waitcnt lgkmcnt(0)
    buffer_store_dwordx4 v[176:179], v62, s[8:11], s37 offen offset:1024
    s_lshl_b32 s26, s18, 2
    s_or_b32 s26, s26, s19
    s_cmp_lg_u32 s26, 0
    s_cbranch_scc1 NOTAG
    v_mov_b32 v232, s41
    v_mov_b32 v233, 425984
    s_mov_b64 exec, 1
    buffer_store_dword v232, v233, s[4:7], 0 offen sc1
NOTAG:
    s_cmp_eq_u32 s25, 0
    s_cbranch_scc1 MAIN_END
    v_mov_b32 v232, s25
    v_mov_b32 v233, 0
    s_mov_b64 exec, 1
    buffer_atomic_or v232, v233, s[12:15], 0 offen
MAIN_END:
    s_endpgm
GCOL0:
    v_lshrrev_b32 v166, 1, v2
    v_cvt_f32_u32 v168, v166
    v_mul_f32 v168, 0x3d000000, v168
    v_add_f32 v168, 0, v168
    v_and_b32 v167, 1, v2
    v_lshrrev_b32 v179, 1, v3
    v_cmp_eq_u32 vcc, v167, v179
    v_mov_b32 v166, 0x3f3504f3
    s_nop 0
    v_cndmask_b32 v175, 0, v166, vcc
    v_mov_b32 v169, 0x3e000000
    v_mov_b32 v176, 0
    s_mov_b32 exec_lo, 0x00030003
    s_mov_b32 exec_hi, 0x00030003
    v_mov_b32 v168, 0.5
    v_cndmask_b32 v175, 0.5, 0, vcc
    v_cvt_f32_u32 v169, v179
    v_mul_f32 v176, v169, v175
    v_mul_f32 v169, 0x3e800000, v169
    s_mov_b64 exec, -1
    v_and_b32 v166, 1, v3
    v_lshl_add_u32 v166, v166, 4, v179
    v_cvt_f32_u32 v166, v166
    v_mul_f32 v166, 0.5, v166
    v_mul_f32 v166, v166, v168
    v_cmp_eq_u32 s[48:49], 0, v3
    v_mul_f32 v177, 0x41800000, v168
    s_nop 0
    v_cndmask_b32 v177, 0, v177, s[48:49]
    v_sub_f32 v170, v166, v169
    v_add_f32 v178, v170, v177
    v_cos_f32 v196, v170
    v_cos_f32 v172, v178
    v_add_f32 v170, v170, v168
    v_fma_f32 v172, v172, v175, v176
    v_cos_f32 v173, v170
    v_add_f32 v170, v170, v168
    v_fma_f32 v173, v173, v175, v176
    v_cvt_pk_f16_f32 v56, v172, v173
    v_cos_f32 v172, v170
    v_add_f32 v170, v170, v168
    v_fma_f32 v172, v172, v175, v176
    v_cos_f32 v173, v170
    v_add_f32 v170, v170, v168
    v_fma_f32 v173, v173, v175, v176
    v_cvt_pk_f16_f32 v57, v172, v173
    v_cos_f32 v172, v170
    v_add_f32 v170, v170, v168
    v_fma_f32 v172, v172, v175, v176
    v_cos_f32 v173, v170
    v_add_f32 v170, v170, v168
    v_fma_f32 v173, v173, v175, v176
    v_cvt_pk_f16_f32 v58, v172, v173
    v_cos_f32 v172, v170
    v_add_f32 v170, v170, v168
    v_fma_f32 v172, v172, v175, v176
    v_cos_f32 v173, v170
    s_nop 0
    v_fma_f32 v173, v173, v175, v176
    v_cvt_pk_f16_f32 v59, v172, v173
    v_fma_f32 v196, v196, v175, v176
    v_cvt_pk_f16_f32 v196, v196, v196
    s_mov_b32 s26, 0xffff
    v_bfi_b32 v64, s26, v196, v56
    v_mov_b32 v65, v57
    v_mov_b64 v[66:67], v[58:59]
    v_sub_f32 v170, 0, v166
    v_sub_f32 v170, v170, v169
    v_sub_f32 v171, 0, v168
    v_add_f32 v178, v170, v177
    v_cos_f32 v196, v178
    v_cos_f32 v172, v170
    v_add_f32 v170, v170, v171
    v_fma_f32 v172, v172, v175, v176
    v_cos_f32 v173, v170
    v_add_f32 v170, v170, v171
    v_fma_f32 v173, v173, v175, v176
    v_cvt_pk_f16_f32 v72, v172, v173
    v_cos_f32 v172, v170
    v_add_f32 v170, v170, v171
    v_fma_f32 v172, v172, v175, v176
    v_cos_f32 v173, v170
    v_add_f32 v170, v170, v171
    v_fma_f32 v173, v173, v175, v176
    v_cvt_pk_f16_f32 v73, v172, v173
    v_cos_f32 v172, v170
    v_add_f32 v170, v170, v171
    v_fma_f32 v172, v172, v175, v176
    v_cos_f32 v173, v170
    v_add_f32 v170, v170, v171
    v_fma_f32 v173, v173, v175, v176
    v_cvt_pk_f16_f32 v74, v172, v173
    v_cos_f32 v172, v170
    v_add_f32 v170, v170, v171
    v_fma_f32 v172, v172, v175, v176
    v_cos_f32 v173, v170
    s_nop 0
    v_fma_f32 v173, v173, v175, v176
    v_cvt_pk_f16_f32 v75, v172, v173
    v_fma_f32 v196, v196, v175, v176
    v_cvt_pk_f16_f32 v196, v196, v196
    v_bfi_b32 v80, s26, v196, v72
    v_mov_b32 v81, v73
    v_mov_b64 v[82:83], v[74:75]
    v_lshrrev_b32 v166, 1, v2
    v_cvt_f32_u32 v168, v166
    v_mul_f32 v168, 0x3d000000, v168
    v_add_f32 v168, 0x3e800000, v168
    v_and_b32 v167, 1, v2
    v_lshrrev_b32 v179, 1, v3
    v_cmp_eq_u32 vcc, v167, v179
    v_mov_b32 v166, 0x3f3504f3
    s_nop 0
    v_cndmask_b32 v175, 0, v166, vcc
    v_mov_b32 v169, 0x3e000000
    v_mov_b32 v176, 0
    v_and_b32 v166, 1, v3
    v_lshl_add_u32 v166, v166, 4, v179
    v_cvt_f32_u32 v166, v166
    v_mul_f32 v166, 0.5, v166
    v_mul_f32 v166, v166, v168
    v_cmp_eq_u32 s[48:49], 0, v3
    v_mul_f32 v177, 0x41800000, v168
    s_nop 0
    v_cndmask_b32 v177, 0, v177, s[48:49]
    v_sub_f32 v170, v166, v169
    v_add_f32 v178, v170, v177
    v_cos_f32 v196, v170
    v_cos_f32 v172, v178
    v_add_f32 v170, v170, v168
    v_fma_f32 v172, v172, v175, v176
    v_cos_f32 v173, v170
    v_add_f32 v170, v170, v168
    v_fma_f32 v173, v173, v175, v176
    v_cvt_pk_f16_f32 v60, v172, v173
    v_cos_f32 v172, v170
    v_add_f32 v170, v170, v168
    v_fma_f32 v172, v172, v175, v176
    v_cos_f32 v173, v170
    v_add_f32 v170, v170, v168
    v_fma_f32 v173, v173, v175, v176
    v_cvt_pk_f16_f32 v61, v172, v173
    v_cos_f32 v172, v170
    v_add_f32 v170, v170, v168
    v_fma_f32 v172, v172, v175, v176
    v_cos_f32 v173, v170
    v_add_f32 v170, v170, v168
    v_fma_f32 v173, v173, v175, v176
    v_cvt_pk_f16_f32 v62, v172, v173
    v_cos_f32 v172, v170
    v_add_f32 v170, v170, v168
    v_fma_f32 v172, v172, v175, v176
    v_cos_f32 v173, v170
    s_nop 0
    v_fma_f32 v173, v173, v175, v176
    v_cvt_pk_f16_f32 v63, v172, v173
    v_fma_f32 v196, v196, v175, v176
    v_cvt_pk_f16_f32 v196, v196, v196
    s_mov_b32 s26, 0xffff
    v_bfi_b32 v68, s26, v196, v60
    v_mov_b32 v69, v61
    v_mov_b64 v[70:71], v[62:63]
    v_sub_f32 v170, 0, v166
    v_sub_f32 v170, v170, v169
    v_sub_f32 v171, 0, v168
    v_add_f32 v178, v170, v177
    v_cos_f32 v196, v178
    v_cos_f32 v172, v170
    v_add_f32 v170, v170, v171
    v_fma_f32 v172, v172, v175, v176
    v_cos_f32 v173, v170
    v_add_f32 v170, v170, v171
    v_fma_f32 v173, v173, v175, v176
    v_cvt_pk_f16_f32 v76, v172, v173
    v_cos_f32 v172, v170
    v_add_f32 v170, v170, v171
    v_fma_f32 v172, v172, v175, v176
    v_cos_f32 v173, v170
    v_add_f32 v170, v170, v171
    v_fma_f32 v173, v173, v175, v176
    v_cvt_pk_f16_f32 v77, v172, v173
    v_cos_f32 v172, v170
    v_add_f32 v170, v170, v171
    v_fma_f32 v172, v172, v175, v176
    v_cos_f32 v173, v170
    v_add_f32 v170, v170, v171
    v_fma_f32 v173, v173, v175, v176
    v_cvt_pk_f16_f32 v78, v172, v173
    v_cos_f32 v172, v170
    v_add_f32 v170, v170, v171
    v_fma_f32 v172, v172, v175, v176
    v_cos_f32 v173, v170
    s_nop 0
    v_fma_f32 v173, v173, v175, v176
    v_cvt_pk_f16_f32 v79, v172, v173
    v_fma_f32 v196, v196, v175, v176
    v_cvt_pk_f16_f32 v196, v196, v196
    v_bfi_b32 v84, s26, v196, v76
    v_mov_b32 v85, v77
    v_mov_b64 v[86:87], v[78:79]
    s_branch GCOL_DONE
GROW0:
    v_cmp_le_u32 vcc, 2, v3
    v_sub_f32 v171, 0, v168
    s_nop 0
    v_cndmask_b32 v171, v168, v171, vcc
    v_sub_f32 v166, 0x42400000, v174
    v_cndmask_b32 v166, v174, v166, vcc
    v_fma_f32 v170, v168, v166, -v169
    v_cmp_eq_u32 s[48:49], 2, v3
    v_mul_f32 v177, 0x41800000, v168
    s_nop 0
    v_cndmask_b32 v177, 0, v177, s[48:49]
    v_sub_f32 v178, v170, v177
    v_cos_f32 v172, v178
    v_add_f32 v170, v170, v171
    v_cos_f32 v173, v170
    v_add_f32 v170, v170, v171
    v_cvt_pk_f16_f32 v88, v172, v173
    v_cos_f32 v172, v170
    v_add_f32 v170, v170, v171
    v_cos_f32 v173, v170
    v_add_f32 v170, v170, v171
    v_cvt_pk_f16_f32 v89, v172, v173
    v_cos_f32 v172, v170
    v_add_f32 v170, v170, v171
    v_cos_f32 v173, v170
    v_add_f32 v170, v170, v171
    v_cvt_pk_f16_f32 v90, v172, v173
    v_cos_f32 v172, v170
    v_add_f32 v170, v170, v171
    v_cos_f32 v173, v170
    s_nop 0
    v_cvt_pk_f16_f32 v91, v172, v173
    v_sub_f32 v166, 0x423c0000, v174
    v_cndmask_b32 v166, v174, v166, vcc
    v_fma_f32 v170, v168, v166, -v169
    v_cos_f32 v172, v170
    v_add_f32 v170, v170, v171
    v_cos_f32 v173, v170
    v_add_f32 v170, v170, v171
    v_cvt_pk_f16_f32 v96, v172, v173
    v_cos_f32 v172, v170
    v_add_f32 v170, v170, v171
    v_cos_f32 v173, v170
    v_add_f32 v170, v170, v171
    v_cvt_pk_f16_f32 v97, v172, v173
    v_cos_f32 v172, v170
    v_add_f32 v170, v170, v171
    v_cos_f32 v173, v170
    v_add_f32 v170, v170, v171
    v_cvt_pk_f16_f32 v98, v172, v173
    v_cos_f32 v172, v170
    v_add_f32 v170, v170, v171
    v_cos_f32 v173, v170
    s_nop 0
    v_cvt_pk_f16_f32 v99, v172, v173
    s_branch GROW_DONE
COL0:
    v_cndmask_b32 v188, v184, v180, s[42:43]
    v_cndmask_b32 v192, v180, v184, s[42:43]
    v_cndmask_b32 v189, v185, v181, s[42:43]
    v_cndmask_b32 v193, v181, v185, s[42:43]
    v_cndmask_b32 v190, v186, v182, s[42:43]
    v_cndmask_b32 v194, v182, v186, s[42:43]
    v_cndmask_b32 v191, v187, v183, s[42:43]
    v_cndmask_b32 v195, v183, v187, s[42:43]
    s_cmp_lg_u32 s30, 0
    s_cbranch_scc1 COL0B
    s_mov_b64 exec, 1
    v_fma_f32 v228, v24, v156, -v157
    v_fma_f32 v229, v48, v156, -v157
    v_fma_f32 v230, v32, v158, -v159
    v_fma_f32 v231, v40, v158, -v159
    v_add_f32 v228, v228, v228
    v_add_f32 v229, v229, v229
    v_add_f32 v230, v230, v230
    v_add_f32 v231, v231, v231
    v_cvt_pk_f16_f32 v180, v228, v165
    v_cvt_pk_f16_f32 v188, v229, v165
    v_cvt_pk_f16_f32 v184, v230, v173
    v_cvt_pk_f16_f32 v192, v231, v173
    s_mov_b64 exec, -1
COL0B:
    v_mfma_f32_16x16x32_f16 v[196:199], v[180:183], v[56:59], 0
    v_mfma_f32_16x16x32_f16 v[200:203], v[180:183], v[60:63], 0
    v_mfma_f32_16x16x32_f16 v[204:207], v[184:187], v[64:67], 0
    v_mfma_f32_16x16x32_f16 v[208:211], v[184:187], v[68:71], 0
    v_mfma_f32_16x16x32_f16 v[196:199], v[188:191], v[72:75], v[196:199]
    v_mfma_f32_16x16x32_f16 v[200:203], v[188:191], v[76:79], v[200:203]
    v_mfma_f32_16x16x32_f16 v[204:207], v[192:195], v[80:83], v[204:207]
    v_mfma_f32_16x16x32_f16 v[208:211], v[192:195], v[84:87], v[208:211]
    s_branch COL_DONE
XTRA:
    s_bitset0_b32 s3, s20
    s_cmp_ge_u32 s20, 2
    s_cbranch_scc1 XT23
    s_add_u32 s26, s21, 262144
    buffer_store_dwordx4 v[20:23], v5, s[4:7], s26 offen sc1
    buffer_store_dwordx4 v[20:23], v5, s[4:7], s26 offen offset:512 sc1
    s_cmp_eq_u32 s20, 1
    s_cbranch_scc1 XT1
    s_cmp_eq_u32 s92, 0
    s_cbranch_scc1 XT0S
    s_lshl_b32 s26, s17, 10
    s_min_u32 s28, s19, 2
    s_mul_i32 s28, s28, 16384
    s_add_u32 s28, s28, s26
    s_add_u32 s28, s28, 458752
    s_add_u32 s28, s28, s50
    s_mov_b64 exec, 0xffff
    buffer_load_dword v251, v250, s[4:7], s28 offen
    s_mov_b64 exec, -1
    s_branch XGO
XT0S:
    s_branch XGO
XT1:
    s_mul_i32 s26, s35, 4096
    s_add_u32 s26, s26, s50
    s_cmp_eq_u32 s92, 0
    s_cselect_b32 s28, 1048576, 0
    s_add_u32 s26, s26, s28
    v_lshlrev_b32 v232, 4, v1
    s_cbranch_scc1 XT1X
    s_cmp_eq_u32 s92, 0
    s_cbranch_scc1 XT1X
    buffer_store_dwordx4 v[20:23], v232, s[4:7], s26 offen offset:0
    buffer_store_dwordx4 v[20:23], v232, s[4:7], s26 offen offset:1024
    buffer_store_dwordx4 v[20:23], v232, s[4:7], s26 offen offset:2048
    buffer_store_dwordx4 v[20:23], v232, s[4:7], s26 offen offset:3072
    s_branch XGO
XT1X:
    buffer_store_dwordx4 v[20:23], v232, s[4:7], s26 offen offset:0 sc1
    buffer_store_dwordx4 v[20:23], v232, s[4:7], s26 offen offset:1024 sc1
    buffer_store_dwordx4 v[20:23], v232, s[4:7], s26 offen offset:2048 sc1
    buffer_store_dwordx4 v[20:23], v232, s[4:7], s26 offen offset:3072 sc1
    s_branch XGO
XT23:
    s_cmp_eq_u32 s20, 3
    s_cbranch_scc1 XT3
    s_cmp_eq_u32 s92, 0
    s_cbranch_scc1 XGO
    s_lshl_b32 s26, s35, 12
    s_add_u32 s26, s26, 0
    s_add_u32 s26, s26, s50
    buffer_load_dword v251, v250, s[4:7], s26 offen
    s_branch XGO
XT3:
    s_mov_b32 s3, 0
    v_lshrrev_b32 v232, 5, v1
    v_lshlrev_b32 v232, 5, v232
    v_lshl_add_u32 v56, v1, 4, v232
    v_add_u32 v56, s38, v56
    v_and_b32 v232, 3, v1
    v_lshlrev_b32 v232, 8, v232
    v_lshrrev_b32 v233, 2, v1
    v_add_u32 v59, v232, v233
    v_and_b32 v232, 1, v1
    v_lshlrev_b32 v232, 8, v232
    v_and_b32 v233, 2, v1
    v_lshl_add_u32 v232, v233, 3, v232
    v_cmp_gt_u32 s[44:45], 4, v1
    s_nop 1
    v_cndmask_b32 v59, v59, v232, s[44:45]
    v_lshrrev_b32 v232, 8, v59
    v_lshlrev_b32 v232, 5, v232
    v_lshl_add_u32 v57, v59, 1, v232
    v_add_u32 v57, s38, v57
    v_sub_u32 v233, 800, v59
    v_lshrrev_b32 v232, 8, v233
    v_lshlrev_b32 v232, 5, v232
    v_lshl_add_u32 v58, v233, 1, v232
    v_add_u32 v58, s38, v58
    v_sub_u32 v233, 1024, v59
    v_and_b32 v233, 1023, v233
    v_lshrrev_b32 v232, 8, v233
    v_lshlrev_b32 v232, 5, v232
    v_lshl_add_u32 v60, v233, 1, v232
    v_add_u32 v60, s38, v60
    v_cmp_eq_u32 s[44:45], 0, v1
    v_mov_b32 v232, 1088
    s_nop 0
    v_cndmask_b32 v232, 0, v232, s[44:45]
    v_add_u32 v59, v57, v232
    v_add_u32 v61, v60, v232
    s_cmp_eq_u32 s36, 0
    s_cselect_b32 s26, 256, 0
    s_add_u32 s39, s26, 512
    s_sub_u32 s40, 768, s26
    s_cmp_eq_u32 s92, 0
    s_cselect_b32 s26, 1048576, 0
    s_add_u32 s39, s39, s26
    s_add_u32 s40, s40, s26
    v_lshlrev_b32 v62, 4, v1
    s_branch XGO3
    s_branch XGO
XCHK:
    buffer_load_dwordx2 v[248:249], v245, s[4:7], s95 offen sc1
    s_waitcnt vmcnt(0)
    v_cmp_ne_u32 vcc, s41, v248
    s_cbranch_vccz XOK
    s_sub_u32 s24, s24, 1
    s_cbranch_scc0 XCHK
    s_or_b32 s25, s25, 32
HSLOW:
    s_mov_b32 s92, 0
    s_mov_b32 s3, 15
    s_add_u32 s51, s51, 1310720
    s_add_u32 s53, s53, 1310720
    s_add_u32 s55, s55, 1310720
    s_mov_b32 s24, 20000
    buffer_store_dwordx4 v[24:27], v246, s[4:7], s51 offen offset:0 sc1
    buffer_store_dwordx4 v[28:31], v246, s[4:7], s51 offen offset:128 sc1
    s_mov_b64 exec, 0xff
    buffer_store_dword v32, v47, s[4:7], s51 offen sc1
    s_mov_b32 exec_lo, 0x01010101
    s_mov_b32 exec_hi, 0x01010101
    buffer_store_dword v33, v46, s[4:7], s51 offen offset:0 sc1
    s_mov_b64 exec, -1
    buffer_store_dwordx4 v[36:39], v246, s[4:7], s53 offen offset:0 sc1
    buffer_store_dwordx4 v[40:43], v246, s[4:7], s53 offen offset:128 sc1
    s_mov_b32 exec_lo, 0x01010101
    s_mov_b32 exec_hi, 0x01010101
    buffer_store_dword v45, v46, s[4:7], s51 offen offset:2048 sc1
    s_mov_b64 exec, -1
    s_waitcnt vmcnt(0)
    s_branch HPOLL
SSLOW:
    buffer_store_dword v164, v6, s[4:7], s23 offen sc1
    s_waitcnt vmcnt(0)
    s_branch SPOLL
FSLOW:
    v_cvt_pk_bf16_f32 v164, v24, v25
    v_cvt_pk_bf16_f32 v165, v26, v27
    v_cvt_pk_bf16_f32 v166, v28, v29
    v_cvt_pk_bf16_f32 v167, v30, v31
    buffer_store_dwordx4 v[164:167], v8, s[4:7], s29 offen offset:0 sc1
    v_cvt_pk_bf16_f32 v168, v32, v33
    v_cvt_pk_bf16_f32 v169, v34, v35
    v_cvt_pk_bf16_f32 v170, v36, v37
    v_cvt_pk_bf16_f32 v171, v38, v39
    buffer_store_dwordx4 v[168:171], v8, s[4:7], s29 offen offset:256 sc1
    v_cvt_pk_bf16_f32 v172, v40, v41
    v_cvt_pk_bf16_f32 v173, v42, v43
    v_cvt_pk_bf16_f32 v174, v44, v45
    v_cvt_pk_bf16_f32 v175, v46, v47
    buffer_store_dwordx4 v[172:175], v8, s[4:7], s29 offen offset:512 sc1
    v_cvt_pk_bf16_f32 v176, v48, v49
    v_cvt_pk_bf16_f32 v177, v50, v51
    v_cvt_pk_bf16_f32 v178, v52, v53
    v_cvt_pk_bf16_f32 v179, v54, v55
    buffer_store_dwordx4 v[176:179], v8, s[4:7], s29 offen offset:768 sc1
    s_waitcnt vmcnt(0)
    s_branch F_DONE
FLAGS:
    s_mov_b32 s24, 20000
    s_waitcnt vmcnt(2)
FLPOLL:
    v_cmp_ne_u32 vcc, s41, v17
    s_cbranch_vccz CLR_DONE
    buffer_load_dword v17, v16, s[4:7], s93 offen sc1
    s_sub_u32 s24, s24, 1
    s_waitcnt vmcnt(0)
    s_cbranch_scc0 FLPOLL
    s_or_b32 s25, s25, 16
    s_branch CLR_DONE
HSPEC:
    v_cndmask_b32 v228, 0, v224, s[42:43]
    v_cndmask_b32 v224, v224, 0, s[42:43]
    v_cndmask_b32 v229, 0, v225, s[42:43]
    v_cndmask_b32 v225, v225, 0, s[42:43]
    v_cndmask_b32 v230, 0, v226, s[42:43]
    v_cndmask_b32 v226, v226, 0, s[42:43]
    v_cndmask_b32 v231, 0, v227, s[42:43]
    v_cndmask_b32 v227, v227, 0, s[42:43]
    v_mfma_f32_16x16x32_f16 v[164:167], v[132:135], v[220:223], 0
    v_mfma_f32_16x16x32_f16 v[168:171], v[136:139], v[220:223], 0
    v_mfma_f32_16x16x32_f16 v[172:175], v[140:143], v[224:227], 0
    v_mfma_f32_16x16x32_f16 v[176:179], v[144:147], v[224:227], 0
    v_mfma_f32_16x16x32_f16 v[172:175], v[132:135], v[228:231], v[172:175]
    v_mfma_f32_16x16x32_f16 v[176:179], v[136:139], v[228:231], v[176:179]
    s_branch H_DONE
EHGEN:
    s_lshr_b32 s26, s19, 1
    s_and_b32 s27, s19, 1
    s_lshl_b32 s28, s26, 5
    s_add_u32 s28, s28, s16
    s_lshl_b32 s29, s27, 10
    s_add_u32 s28, s28, s29
    s_add_u32 s29, s29, 16
    s_lshl_b32 s27, s27, 5
    s_cmp_eq_u32 s26, 1
    s_cselect_b32 s27, s29, s27
    s_cselect_b32 s31, 0, 0x3d800000
    s_cselect_b32 s33, 0x3d800000, 0
    s_cmp_eq_u32 s16, 0
    s_cselect_b32 s28, s27, s28
    s_cselect_b32 s31, s31, 0x3d800000
    s_cselect_b32 s33, s33, 0
    s_cselect_b32 s32, 0, 0xbd800000
    s_cselect_b32 s34, 0, 0x3d800000
    v_lshlrev_b32 v164, 6, v2
    v_add_u32 v164, s28, v164
    v_cvt_f32_u32 v164, v164
    v_cvt_f32_u32 v172, v3
    v_mul_f32 v164, 0x3a000000, v164
    v_mul_f32 v165, 0x42000000, v164
    v_cmp_eq_u32 s[48:49], 0, v3
    s_mov_b32 s26, 0x80008000
    v_mul_f32 v166, v164, v172
    v_mul_f32 v173, 0.5, v165
    v_cndmask_b32 v173, v165, v173, s[48:49]
    v_add_f32 v173, v173, v166
    v_cndmask_b32 v174, v166, v165, s[48:49]
    v_mov_b32 v175, s26
    v_cndmask_b32 v175, v175, 0, s[48:49]
    v_cos_f32 v168, v166
    v_sin_f32 v169, v166
    v_mul_f32 v170, s31, v168
    v_mul_f32 v171, s33, v168
    v_fmac_f32 v171, s32, v169
    v_cvt_pk_f16_f32 v100, v170, v171
    v_mul_f32 v170, s31, v169
    v_mul_f32 v171, s33, v169
    v_fmac_f32 v171, s34, v168
    v_cvt_pk_f16_f32 v116, v170, v171
    v_cos_f32 v168, v173
    v_sin_f32 v169, v173
    v_mul_f32 v170, s31, v168
    v_mul_f32 v171, s33, v168
    v_fmac_f32 v171, s32, v169
    v_cvt_pk_f16_f32 v101, v170, v171
    v_mul_f32 v170, s31, v169
    v_mul_f32 v171, s33, v169
    v_fmac_f32 v171, s34, v168
    v_cvt_pk_f16_f32 v117, v170, v171
    v_cos_f32 v168, v174
    v_sin_f32 v169, v174
    v_mul_f32 v170, s31, v168
    v_mul_f32 v171, s33, v168
    v_fmac_f32 v171, s32, v169
    v_cvt_pk_f16_f32 v102, v170, v171
    v_mul_f32 v170, s31, v169
    v_mul_f32 v171, s33, v169
    v_fmac_f32 v171, s34, v168
    v_cvt_pk_f16_f32 v118, v170, v171
    v_xor_b32 v118, v175, v118
    v_mov_b32 v103, v101
    v_xor_b32 v119, s26, v117
    v_fmac_f32 v166, 4.0, v164
    v_add_f32 v173, v166, v165
    v_cos_f32 v168, v166
    v_sin_f32 v169, v166
    v_mul_f32 v170, s31, v168
    v_mul_f32 v171, s33, v168
    v_fmac_f32 v171, s32, v169
    v_cvt_pk_f16_f32 v104, v170, v171
    v_mul_f32 v170, s31, v169
    v_mul_f32 v171, s33, v169
    v_fmac_f32 v171, s34, v168
    v_cvt_pk_f16_f32 v120, v170, v171
    v_cos_f32 v168, v173
    v_sin_f32 v169, v173
    v_mul_f32 v170, s31, v168
    v_mul_f32 v171, s33, v168
    v_fmac_f32 v171, s32, v169
    v_cvt_pk_f16_f32 v105, v170, v171
    v_mul_f32 v170, s31, v169
    v_mul_f32 v171, s33, v169
    v_fmac_f32 v171, s34, v168
    v_cvt_pk_f16_f32 v121, v170, v171
    v_mov_b64 v[106:107], v[104:105]
    v_xor_b32 v122, s26, v120
    v_xor_b32 v123, s26, v121
    v_fmac_f32 v166, 4.0, v164
    v_add_f32 v173, v166, v165
    v_cos_f32 v168, v166
    v_sin_f32 v169, v166
    v_mul_f32 v170, s31, v168
    v_mul_f32 v171, s33, v168
    v_fmac_f32 v171, s32, v169
    v_cvt_pk_f16_f32 v108, v170, v171
    v_mul_f32 v170, s31, v169
    v_mul_f32 v171, s33, v169
    v_fmac_f32 v171, s34, v168
    v_cvt_pk_f16_f32 v124, v170, v171
    v_cos_f32 v168, v173
    v_sin_f32 v169, v173
    v_mul_f32 v170, s31, v168
    v_mul_f32 v171, s33, v168
    v_fmac_f32 v171, s32, v169
    v_cvt_pk_f16_f32 v109, v170, v171
    v_mul_f32 v170, s31, v169
    v_mul_f32 v171, s33, v169
    v_fmac_f32 v171, s34, v168
    v_cvt_pk_f16_f32 v125, v170, v171
    v_mov_b64 v[110:111], v[108:109]
    v_xor_b32 v126, s26, v124
    v_xor_b32 v127, s26, v125
    v_fmac_f32 v166, 4.0, v164
    v_add_f32 v173, v166, v165
    v_cos_f32 v168, v166
    v_sin_f32 v169, v166
    v_mul_f32 v170, s31, v168
    v_mul_f32 v171, s33, v168
    v_fmac_f32 v171, s32, v169
    v_cvt_pk_f16_f32 v112, v170, v171
    v_mul_f32 v170, s31, v169
    v_mul_f32 v171, s33, v169
    v_fmac_f32 v171, s34, v168
    v_cvt_pk_f16_f32 v128, v170, v171
    v_cos_f32 v168, v173
    v_sin_f32 v169, v173
    v_mul_f32 v170, s31, v168
    v_mul_f32 v171, s33, v168
    v_fmac_f32 v171, s32, v169
    v_cvt_pk_f16_f32 v113, v170, v171
    v_mul_f32 v170, s31, v169
    v_mul_f32 v171, s33, v169
    v_fmac_f32 v171, s34, v168
    v_cvt_pk_f16_f32 v129, v170, v171
    v_mov_b64 v[114:115], v[112:113]
    v_xor_b32 v130, s26, v128
    v_xor_b32 v131, s26, v129
    s_and_b32 exec_lo, s42, 0x00010000
    s_mov_b32 exec_hi, exec_lo
    v_mov_b32 v100, 0
    v_mov_b32 v116, 0xac00
    v_mov_b32 v101, 0
    v_mov_b32 v117, 0xac00
    v_mov_b32 v102, 0
    v_mov_b32 v118, 0xac00
    v_mov_b32 v103, 0
    v_mov_b32 v119, 0xac00
    v_mov_b32 v104, 0
    v_mov_b32 v120, 0xac00
    v_mov_b32 v105, 0
    v_mov_b32 v121, 0xac00
    v_mov_b32 v106, 0
    v_mov_b32 v122, 0xac00
    v_mov_b32 v107, 0
    v_mov_b32 v123, 0xac00
    v_mov_b32 v108, 0
    v_mov_b32 v124, 0xac00
    v_mov_b32 v109, 0
    v_mov_b32 v125, 0xac00
    v_mov_b32 v110, 0
    v_mov_b32 v126, 0xac00
    v_mov_b32 v111, 0
    v_mov_b32 v127, 0xac00
    v_mov_b32 v112, 0
    v_mov_b32 v128, 0xac00
    v_mov_b32 v113, 0
    v_mov_b32 v129, 0xac00
    v_mov_b32 v114, 0
    v_mov_b32 v130, 0xac00
    v_mov_b32 v115, 0
    v_mov_b32 v131, 0xac00
    s_mov_b64 exec, -1
    v_lshrrev_b32 v186, 2, v2
    v_lshlrev_b32 v186, 3, v186
    v_and_b32 v170, 3, v2
    v_add_u32 v186, v186, v170
    v_lshlrev_b32 v180, 5, v186
    v_add_u32 v180, s17, v180
    v_add_u32 v181, 128, v180
    v_mov_b32 v176, 0x41800000
    v_mov_b32 v177, 0xc1800000
    v_mov_b32 v178, 0
    v_mov_b32 v179, 0
    s_cmp_eq_u32 s17, 0
    s_cselect_b32 exec_lo, 0xff00ff00, 0
    s_mov_b32 exec_hi, exec_lo
    v_subrev_u32 v180, 496, v180
    v_subrev_u32 v181, 496, v181
    v_mov_b32 v176, 0
    v_mov_b32 v177, 0
    v_mov_b32 v178, 0x41800000
    s_cselect_b32 exec_lo, 0x00ff00ff, 0
    s_mov_b32 exec_hi, exec_lo
    v_mov_b32 v177, 0
    v_mov_b32 v179, 0xc1800000
    s_cselect_b32 exec_lo, 0x00010001, 0
    s_mov_b32 exec_hi, exec_lo
    v_mov_b32 v180, 512
    s_mov_b64 exec, -1
    v_cvt_f32_u32 v180, v180
    v_cvt_f32_u32 v181, v181
    v_sub_f32 v188, 0, v177
    v_mul_f32 v180, 0x3a800000, v180
    v_mul_f32 v181, 0x3a800000, v181
    v_add_f32 v182, v172, v172
    v_add_f32 v183, 1.0, v182
    v_add_f32 v184, 0x41000000, v182
    v_add_f32 v185, 0x41100000, v182
    v_mul_f32 v166, v180, v182
    v_cos_f32 v168, v166
    v_sin_f32 v169, v166
    v_fma_f32 v170, v176, v168, v179
    v_mul_f32 v171, v178, v168
    v_fmac_f32 v171, v177, v169
    v_cvt_pk_f16_f32 v132, v170, v171
    v_mul_f32 v170, v176, v169
    v_mul_f32 v171, v178, v169
    v_fmac_f32 v171, v188, v168
    v_cvt_pk_f16_f32 v140, v170, v171
    v_mul_f32 v166, v180, v183
    v_cos_f32 v168, v166
    v_sin_f32 v169, v166
    v_fma_f32 v170, v176, v168, v179
    v_mul_f32 v171, v178, v168
    v_fmac_f32 v171, v177, v169
    v_cvt_pk_f16_f32 v133, v170, v171
    v_mul_f32 v170, v176, v169
    v_mul_f32 v171, v178, v169
    v_fmac_f32 v171, v188, v168
    v_cvt_pk_f16_f32 v141, v170, v171
    v_mul_f32 v166, v180, v184
    v_cos_f32 v168, v166
    v_sin_f32 v169, v166
    v_fma_f32 v170, v176, v168, v179
    v_mul_f32 v171, v178, v168
    v_fmac_f32 v171, v177, v169
    v_cvt_pk_f16_f32 v134, v170, v171
    v_mul_f32 v170, v176, v169
    v_mul_f32 v171, v178, v169
    v_fmac_f32 v171, v188, v168
    v_cvt_pk_f16_f32 v142, v170, v171
    v_mul_f32 v166, v180, v185
    v_cos_f32 v168, v166
    v_sin_f32 v169, v166
    v_fma_f32 v170, v176, v168, v179
    v_mul_f32 v171, v178, v168
    v_fmac_f32 v171, v177, v169
    v_cvt_pk_f16_f32 v135, v170, v171
    v_mul_f32 v170, v176, v169
    v_mul_f32 v171, v178, v169
    v_fmac_f32 v171, v188, v168
    v_cvt_pk_f16_f32 v143, v170, v171
    v_mul_f32 v166, v181, v182
    v_cos_f32 v168, v166
    v_sin_f32 v169, v166
    v_fma_f32 v170, v176, v168, v179
    v_mul_f32 v171, v178, v168
    v_fmac_f32 v171, v177, v169
    v_cvt_pk_f16_f32 v136, v170, v171
    v_mul_f32 v170, v176, v169
    v_mul_f32 v171, v178, v169
    v_fmac_f32 v171, v188, v168
    v_cvt_pk_f16_f32 v144, v170, v171
    v_mul_f32 v166, v181, v183
    v_cos_f32 v168, v166
    v_sin_f32 v169, v166
    v_fma_f32 v170, v176, v168, v179
    v_mul_f32 v171, v178, v168
    v_fmac_f32 v171, v177, v169
    v_cvt_pk_f16_f32 v137, v170, v171
    v_mul_f32 v170, v176, v169
    v_mul_f32 v171, v178, v169
    v_fmac_f32 v171, v188, v168
    v_cvt_pk_f16_f32 v145, v170, v171
    v_mul_f32 v166, v181, v184
    v_cos_f32 v168, v166
    v_sin_f32 v169, v166
    v_fma_f32 v170, v176, v168, v179
    v_mul_f32 v171, v178, v168
    v_fmac_f32 v171, v177, v169
    v_cvt_pk_f16_f32 v138, v170, v171
    v_mul_f32 v170, v176, v169
    v_mul_f32 v171, v178, v169
    v_fmac_f32 v171, v188, v168
    v_cvt_pk_f16_f32 v146, v170, v171
    v_mul_f32 v166, v181, v185
    v_cos_f32 v168, v166
    v_sin_f32 v169, v166
    v_fma_f32 v170, v176, v168, v179
    v_mul_f32 v171, v178, v168
    v_fmac_f32 v171, v177, v169
    v_cvt_pk_f16_f32 v139, v170, v171
    v_mul_f32 v170, v176, v169
    v_mul_f32 v171, v178, v169
    v_fmac_f32 v171, v188, v168
    v_cvt_pk_f16_f32 v147, v170, v171
    v_and_b32 v187, 1, v2
    v_cvt_f32_u32 v187, v187
    v_fma_f32 v187, v187, -2.0, 1.0
    v_add_f32 v170, v188, v179
    v_fma_f32 v170, -v179, v187, v170
    v_fma_f32 v171, v188, v187, v178
    v_fma_f32 v168, v178, v187, v188
    v_mul_f32 v169, v188, v187
    s_mov_b64 exec, 0xffff
    v_cvt_pk_f16_f32 v132, v170, v171
    v_cvt_pk_f16_f32 v136, v170, v171
    v_cvt_pk_f16_f32 v140, v168, v169
    v_cvt_pk_f16_f32 v144, v168, v169
    s_mov_b64 exec, -1
    s_branch EH_DONE
.section .rodata,"a"
.p2align 6
.amdhsa_kernel interleave_layers__spectral_fnet__spectral_fnet__prompt_kernel
  .amdhsa_next_free_vgpr 256
  .amdhsa_next_free_sgpr 96
  .amdhsa_accum_offset 256
  .amdhsa_group_segment_fixed_size 0
  .amdhsa_kernarg_size 104
  .amdhsa_user_sgpr_count 2
  .amdhsa_user_sgpr_kernarg_segment_ptr 1
  .amdhsa_system_sgpr_workgroup_id_x 1
.end_amdhsa_kernel
```
